```python
import torch

def _softmax(x, axis=-1):
    return torch.softmax(x, dim=axis)
def _gelu(x):
    return torch.nn.functional.gelu(x, approximate="tanh")
def _silu(x):
    return torch.nn.functional.silu(x)
def _sigmoid(x):
    return torch.sigmoid(x)
def _layernorm(x, axis=-1, eps=1e-5):
    m = x.mean(dim=axis, keepdim=True)
    v = x.var(dim=axis, keepdim=True, unbiased=False)
    return (x - m) / torch.sqrt(v + eps)
def _scatter_add(tgt, idx, src, axis=0):
    return tgt.clone().index_add_(axis, idx, src)
def _segment_sum(src, seg, n):
    out = torch.zeros((n,) + src.shape[1:], dtype=src.dtype)
    return out.index_add_(0, seg, src)
def _pad(x, pw):
    flat = tuple(v for pair in reversed(pw) for v in pair)
    return torch.nn.functional.pad(x, flat)

kernel_name = 'standalone__gqa_block_cached__near_ridge'

def setup_inputs():

    _w = (lambda a: (lambda t: t.to(torch.bfloat16) if t.is_floating_point() else t)(torch.as_tensor(a)))
    B, Sq, D = 8, 128, 448
    Hq, Hkv, Sk, Dh = 16, 8, 512, 256
    assert Hq % Hkv == 0, (Hq, Hkv)
    return {
        "x": _w((lambda *s: torch.randn(*s, dtype=torch.bfloat16) * 0.8)(B, Sq, D)),
        "k_cache": _w((lambda *s: torch.randn(*s, dtype=torch.bfloat16) * 0.8)(B, Hkv, Sk, Dh)),
        "v_cache": _w((lambda *s: torch.randn(*s, dtype=torch.bfloat16) * 0.05)(B, Hkv, Sk, Dh)),
        "wq": _w((lambda *s: torch.randn(*s, dtype=torch.bfloat16) * 0.8)(D, Hq * Dh) * (D ** -0.5)),
        "wo": _w((lambda *s: torch.randn(*s, dtype=torch.bfloat16) * 0.05)(Hq * Dh, D) * ((Hq * Dh) ** -0.5)),
    }

def reference(x, k_cache, v_cache, wq, wo):
    B, Sq, D = x.shape
    Hq, Dh = 16, 256
    Hkv = k_cache.shape[1]
    rep = Hq // Hkv
    q = (lambda x, *d: x.permute(*d))((x @ wq).reshape(B, Sq, Hq, Dh), 0, 2, 1, 3)
    k = (lambda x, n, axis: torch.repeat_interleave(x, n, dim=axis))(k_cache, rep, axis=1)
    v = (lambda x, n, axis: torch.repeat_interleave(x, n, dim=axis))(v_cache, rep, axis=1)
    scores = torch.einsum("bhqd,bhkd->bhqk", q, k) * (Dh ** -0.5)
    p = _softmax(scores, axis=-1)
    o = torch.einsum("bhqk,bhkd->bhqd", p, v)
    return (lambda x, *d: x.permute(*d))(o, 0, 2, 1, 3).reshape(B, Sq, Hq * Dh) @ wo
```

```asm
; @launch kernel=standalone__gqa_block_cached__near_ridge_kernel grid=(256,1,1) block=(512,1,1) lds=163840
; @launch kernel=gqa_reduce_kernel grid=(224,1,1) block=(256,1,1) lds=0
.amdgcn_target "amdgcn-amd-amdhsa--gfx950"
.text
.globl standalone__gqa_block_cached__near_ridge_kernel
.p2align 8
.type standalone__gqa_block_cached__near_ridge_kernel,@function
standalone__gqa_block_cached__near_ridge_kernel:
L_code0:
    s_cmp_ge_u32 s2, 256
    s_cbranch_scc1 L_end
    s_load_dwordx16 s[4:19], s[0:1], 0
    v_lshrrev_b32 v4, 6, v0
    v_and_b32 v0, 63, v0
    v_readfirstlane_b32 s51, v4
    s_lshr_b32 s54, s2, 3
    s_lshr_b32 s55, s54, 2
    s_bfe_u32 s57, s54, 0x10001
    s_lshl_b32 s59, s55, 1
    s_add_u32 s59, s59, s57
    s_and_b32 s53, s2, 7
    s_and_b32 s56, s54, 1
    s_lshl_b32 s58, s53, 1
    s_add_u32 s58, s58, s56
    s_and_b32 s44, s51, 3
    s_mul_i32 s45, s44, 24576
    s_add_u32 s45, s45, 65536
    s_cmp_ge_u32 s51, 4
    s_cbranch_scc1 L_loader
    v_lshlrev_b32 v1, 4, v0
    v_lshrrev_b32 v36, 5, v0
    v_bfe_u32 v37, v0, 2, 2
    v_bfe_u32 v38, v0, 4, 1
    v_and_b32 v39, 3, v0
    v_lshrrev_b32 v32, 1, v39
    v_and_b32 v33, 1, v39
    v_lshl_or_b32 v40, v33, 1, v32
    v_lshrrev_b32 v41, 1, v37
    v_lshlrev_b32 v41, 6, v41
    v_bfe_u32 v32, v0, 1, 3
    v_xor_b32 v32, v32, v36
    v_and_b32 v33, 31, v0
    v_lshlrev_b32 v33, 7, v33
    v_xor_b32 v34, 0, v32
    v_lshl_add_u32 v5, v34, 4, v33
    v_add_u32 v9, s45, v5
    v_xor_b32 v34, 2, v32
    v_lshl_add_u32 v6, v34, 4, v33
    v_add_u32 v10, s45, v6
    v_xor_b32 v34, 4, v32
    v_lshl_add_u32 v7, v34, 4, v33
    v_add_u32 v11, s45, v7
    v_xor_b32 v34, 6, v32
    v_lshl_add_u32 v8, v34, 4, v33
    v_add_u32 v12, s45, v8
    v_lshlrev_b32 v32, 5, v38
    v_lshl_add_u32 v33, v40, 3, v32
    v_lshl_add_u32 v34, v39, 3, v32
    v_lshlrev_b32 v35, 7, v37
    v_xor_b32 v32, 0, v41
    v_add3_u32 v13, v32, v33, v35
    v_lshl_add_u32 v13, v36, 10, v13
    v_add_u32 v13, s45, v13
    v_add3_u32 v15, v32, v34, v35
    v_lshl_add_u32 v15, v36, 9, v15
    v_add_u32 v15, s45, v15
    v_xor_b32 v32, 64, v41
    v_add3_u32 v14, v32, v33, v35
    v_lshl_add_u32 v14, v36, 10, v14
    v_add_u32 v14, s45, v14
    v_add3_u32 v16, v32, v34, v35
    v_lshl_add_u32 v16, v36, 9, v16
    v_add_u32 v16, s45, v16
    s_and_b32 s48, s44, 1
    s_lshl_b32 s48, s48, 6
    v_xor_b32 v32, s48, v41
    v_add3_u32 v19, v32, v33, v35
    v_lshl_add_u32 v19, v36, 9, v19
    v_add_u32 v17, 65536, v19
    v_add_u32 v18, 114688, v19
    s_lshr_b32 s48, s44, 1
    s_lshl_b32 s47, s48, 14
    v_add_u32 v20, s47, v1
    s_lshl_b32 s47, s44, 11
    v_add_u32 v21, s47, v1
    s_lshl_b32 s47, s44, 12
    v_add_u32 v2, s47, v1
    v_and_b32 v32, 31, v0
    v_lshlrev_b32 v32, 4, v32
    v_add_u32 v4, 61440, v32
    s_lshl_b32 s47, s44, 2
    v_add_u32 v3, s47, v4
    s_lshl_b32 s47, s48, 9
    v_add_u32 v22, s47, v4
    s_mov_b32 s49, 0x3db8aa3b
    s_mul_i32 s47, s59, 7
    s_lshr_b32 s47, s47, 4
    s_add_u32 s48, s47, 0
    s_cmp_ge_u32 s48, 7
    s_cselect_b32 s46, 7, 0
    s_sub_u32 s48, s48, s46
    s_lshl_b32 s91, s48, 13
    s_add_u32 s48, s47, 1
    s_cmp_ge_u32 s48, 7
    s_cselect_b32 s46, 7, 0
    s_sub_u32 s48, s48, s46
    s_lshl_b32 s92, s48, 13
    s_add_u32 s48, s47, 2
    s_cmp_ge_u32 s48, 7
    s_cselect_b32 s46, 7, 0
    s_sub_u32 s48, s48, s46
    s_lshl_b32 s93, s48, 13
    s_add_u32 s48, s47, 3
    s_cmp_ge_u32 s48, 7
    s_cselect_b32 s46, 7, 0
    s_sub_u32 s48, s48, s46
    s_lshl_b32 s94, s48, 13
    s_add_u32 s48, s47, 4
    s_cmp_ge_u32 s48, 7
    s_cselect_b32 s46, 7, 0
    s_sub_u32 s48, s48, s46
    s_lshl_b32 s95, s48, 13
    s_add_u32 s48, s47, 5
    s_cmp_ge_u32 s48, 7
    s_cselect_b32 s46, 7, 0
    s_sub_u32 s48, s48, s46
    s_lshl_b32 s96, s48, 13
    s_add_u32 s48, s47, 6
    s_cmp_ge_u32 s48, 7
    s_cselect_b32 s46, 7, 0
    s_sub_u32 s48, s48, s46
    s_lshl_b32 s97, s48, 13
    s_mul_i32 s63, s2, 57344
    s_waitcnt lgkmcnt(0)
    s_add_u32 s40, s18, s63
    s_addc_u32 s41, s19, 0
    s_and_b32 s41, s41, 0xffff
    s_mov_b32 s42, 57344
    s_mov_b32 s43, 0x20000
    s_barrier
    ds_read_b64_tr_b16 v[192:193], v13 offset:0
    ds_read_b64_tr_b16 v[194:195], v13 offset:512
    ds_read_b64_tr_b16 v[196:197], v14 offset:0
    ds_read_b64_tr_b16 v[198:199], v14 offset:512
    ds_read_b128 v[200:203], v5 offset:0
    ds_read_b128 v[204:207], v5 offset:4096
    ds_read_b64_tr_b16 v[208:209], v13 offset:2048
    ds_read_b64_tr_b16 v[210:211], v13 offset:2560
    ds_read_b64_tr_b16 v[212:213], v14 offset:2048
    ds_read_b64_tr_b16 v[214:215], v14 offset:2560
    ds_read_b128 v[216:219], v6 offset:0
    ds_read_b128 v[220:223], v6 offset:4096
    s_waitcnt lgkmcnt(6)
    v_mfma_f32_32x32x16_bf16 v[128:143], v[192:195], v[200:203], 0
    ds_read_b64_tr_b16 v[224:225], v13 offset:4096
    ds_read_b64_tr_b16 v[226:227], v13 offset:4608
    v_mfma_f32_32x32x16_bf16 v[144:159], v[192:195], v[204:207], 0
    ds_read_b64_tr_b16 v[228:229], v14 offset:4096
    ds_read_b64_tr_b16 v[230:231], v14 offset:4608
    v_mfma_f32_32x32x16_bf16 v[160:175], v[196:199], v[200:203], 0
    ds_read_b128 v[232:235], v7 offset:0
    ds_read_b128 v[236:239], v7 offset:4096
    v_mfma_f32_32x32x16_bf16 v[176:191], v[196:199], v[204:207], 0
    s_waitcnt lgkmcnt(6)
    v_mfma_f32_32x32x16_bf16 v[128:143], v[208:211], v[216:219], v[128:143]
    ds_read_b64_tr_b16 v[192:193], v13 offset:6144
    ds_read_b64_tr_b16 v[194:195], v13 offset:6656
    v_mfma_f32_32x32x16_bf16 v[144:159], v[208:211], v[220:223], v[144:159]
    ds_read_b64_tr_b16 v[196:197], v14 offset:6144
    ds_read_b64_tr_b16 v[198:199], v14 offset:6656
    v_mfma_f32_32x32x16_bf16 v[160:175], v[212:215], v[216:219], v[160:175]
    ds_read_b128 v[200:203], v8 offset:0
    ds_read_b128 v[204:207], v8 offset:4096
    v_mfma_f32_32x32x16_bf16 v[176:191], v[212:215], v[220:223], v[176:191]
    s_waitcnt lgkmcnt(6)
    v_mfma_f32_32x32x16_bf16 v[128:143], v[224:227], v[232:235], v[128:143]
    v_mfma_f32_32x32x16_bf16 v[144:159], v[224:227], v[236:239], v[144:159]
    s_waitcnt lgkmcnt(0)
    s_barrier
    ds_read_b64_tr_b16 v[208:209], v13 offset:8192
    ds_read_b64_tr_b16 v[210:211], v13 offset:8704
    v_mfma_f32_32x32x16_bf16 v[160:175], v[228:231], v[232:235], v[160:175]
    ds_read_b64_tr_b16 v[212:213], v14 offset:8192
    ds_read_b64_tr_b16 v[214:215], v14 offset:8704
    v_mfma_f32_32x32x16_bf16 v[176:191], v[228:231], v[236:239], v[176:191]
    ds_read_b128 v[216:219], v5 offset:8192
    ds_read_b128 v[220:223], v5 offset:12288
    v_mfma_f32_32x32x16_bf16 v[128:143], v[192:195], v[200:203], v[128:143]
    ds_read_b64_tr_b16 v[224:225], v13 offset:10240
    ds_read_b64_tr_b16 v[226:227], v13 offset:10752
    v_mfma_f32_32x32x16_bf16 v[144:159], v[192:195], v[204:207], v[144:159]
    ds_read_b64_tr_b16 v[228:229], v14 offset:10240
    ds_read_b64_tr_b16 v[230:231], v14 offset:10752
    v_mfma_f32_32x32x16_bf16 v[160:175], v[196:199], v[200:203], v[160:175]
    ds_read_b128 v[232:235], v6 offset:8192
    ds_read_b128 v[236:239], v6 offset:12288
    v_mfma_f32_32x32x16_bf16 v[176:191], v[196:199], v[204:207], v[176:191]
    s_waitcnt lgkmcnt(6)
    v_mfma_f32_32x32x16_bf16 v[128:143], v[208:211], v[216:219], v[128:143]
    ds_read_b64_tr_b16 v[192:193], v13 offset:12288
    ds_read_b64_tr_b16 v[194:195], v13 offset:12800
    v_mfma_f32_32x32x16_bf16 v[144:159], v[208:211], v[220:223], v[144:159]
    ds_read_b64_tr_b16 v[196:197], v14 offset:12288
    ds_read_b64_tr_b16 v[198:199], v14 offset:12800
    v_mfma_f32_32x32x16_bf16 v[160:175], v[212:215], v[216:219], v[160:175]
    ds_read_b128 v[200:203], v7 offset:8192
    ds_read_b128 v[204:207], v7 offset:12288
    v_mfma_f32_32x32x16_bf16 v[176:191], v[212:215], v[220:223], v[176:191]
    s_waitcnt lgkmcnt(6)
    v_mfma_f32_32x32x16_bf16 v[128:143], v[224:227], v[232:235], v[128:143]
    ds_read_b64_tr_b16 v[208:209], v13 offset:14336
    ds_read_b64_tr_b16 v[210:211], v13 offset:14848
    v_mfma_f32_32x32x16_bf16 v[144:159], v[224:227], v[236:239], v[144:159]
    ds_read_b64_tr_b16 v[212:213], v14 offset:14336
    ds_read_b64_tr_b16 v[214:215], v14 offset:14848
    v_mfma_f32_32x32x16_bf16 v[160:175], v[228:231], v[232:235], v[160:175]
    ds_read_b128 v[216:219], v8 offset:8192
    ds_read_b128 v[220:223], v8 offset:12288
    v_mfma_f32_32x32x16_bf16 v[176:191], v[228:231], v[236:239], v[176:191]
    s_waitcnt lgkmcnt(6)
    v_mfma_f32_32x32x16_bf16 v[128:143], v[192:195], v[200:203], v[128:143]
    v_mfma_f32_32x32x16_bf16 v[144:159], v[192:195], v[204:207], v[144:159]
    s_waitcnt lgkmcnt(0)
    s_barrier
    ds_read_b64_tr_b16 v[224:225], v13 offset:16384
    ds_read_b64_tr_b16 v[226:227], v13 offset:16896
    v_mfma_f32_32x32x16_bf16 v[160:175], v[196:199], v[200:203], v[160:175]
    ds_read_b64_tr_b16 v[228:229], v14 offset:16384
    ds_read_b64_tr_b16 v[230:231], v14 offset:16896
    v_mfma_f32_32x32x16_bf16 v[176:191], v[196:199], v[204:207], v[176:191]
    ds_read_b128 v[232:235], v5 offset:16384
    ds_read_b128 v[236:239], v5 offset:20480
    v_mfma_f32_32x32x16_bf16 v[128:143], v[208:211], v[216:219], v[128:143]
    ds_read_b64_tr_b16 v[192:193], v13 offset:18432
    ds_read_b64_tr_b16 v[194:195], v13 offset:18944
    v_mfma_f32_32x32x16_bf16 v[144:159], v[208:211], v[220:223], v[144:159]
    ds_read_b64_tr_b16 v[196:197], v14 offset:18432
    ds_read_b64_tr_b16 v[198:199], v14 offset:18944
    v_mfma_f32_32x32x16_bf16 v[160:175], v[212:215], v[216:219], v[160:175]
    ds_read_b128 v[200:203], v6 offset:16384
    ds_read_b128 v[204:207], v6 offset:20480
    v_mfma_f32_32x32x16_bf16 v[176:191], v[212:215], v[220:223], v[176:191]
    s_waitcnt lgkmcnt(6)
    v_mfma_f32_32x32x16_bf16 v[128:143], v[224:227], v[232:235], v[128:143]
    ds_read_b64_tr_b16 v[208:209], v13 offset:20480
    ds_read_b64_tr_b16 v[210:211], v13 offset:20992
    v_mfma_f32_32x32x16_bf16 v[144:159], v[224:227], v[236:239], v[144:159]
    ds_read_b64_tr_b16 v[212:213], v14 offset:20480
    ds_read_b64_tr_b16 v[214:215], v14 offset:20992
    v_mfma_f32_32x32x16_bf16 v[160:175], v[228:231], v[232:235], v[160:175]
    ds_read_b128 v[216:219], v7 offset:16384
    ds_read_b128 v[220:223], v7 offset:20480
    v_mfma_f32_32x32x16_bf16 v[176:191], v[228:231], v[236:239], v[176:191]
    s_waitcnt lgkmcnt(6)
    v_mfma_f32_32x32x16_bf16 v[128:143], v[192:195], v[200:203], v[128:143]
    ds_read_b64_tr_b16 v[224:225], v13 offset:22528
    ds_read_b64_tr_b16 v[226:227], v13 offset:23040
    v_mfma_f32_32x32x16_bf16 v[144:159], v[192:195], v[204:207], v[144:159]
    ds_read_b64_tr_b16 v[228:229], v14 offset:22528
    ds_read_b64_tr_b16 v[230:231], v14 offset:23040
    v_mfma_f32_32x32x16_bf16 v[160:175], v[196:199], v[200:203], v[160:175]
    ds_read_b128 v[232:235], v8 offset:16384
    ds_read_b128 v[236:239], v8 offset:20480
    v_mfma_f32_32x32x16_bf16 v[176:191], v[196:199], v[204:207], v[176:191]
    s_waitcnt lgkmcnt(6)
    v_mfma_f32_32x32x16_bf16 v[128:143], v[208:211], v[216:219], v[128:143]
    v_mfma_f32_32x32x16_bf16 v[144:159], v[208:211], v[220:223], v[144:159]
    s_waitcnt lgkmcnt(0)
    s_barrier
    ds_read_b64_tr_b16 v[192:193], v13 offset:0
    ds_read_b64_tr_b16 v[194:195], v13 offset:512
    v_mfma_f32_32x32x16_bf16 v[160:175], v[212:215], v[216:219], v[160:175]
    ds_read_b64_tr_b16 v[196:197], v14 offset:0
    ds_read_b64_tr_b16 v[198:199], v14 offset:512
    v_mfma_f32_32x32x16_bf16 v[176:191], v[212:215], v[220:223], v[176:191]
    ds_read_b128 v[200:203], v5 offset:24576
    ds_read_b128 v[204:207], v5 offset:28672
    v_mfma_f32_32x32x16_bf16 v[128:143], v[224:227], v[232:235], v[128:143]
    ds_read_b64_tr_b16 v[208:209], v13 offset:2048
    ds_read_b64_tr_b16 v[210:211], v13 offset:2560
    v_mfma_f32_32x32x16_bf16 v[144:159], v[224:227], v[236:239], v[144:159]
    ds_read_b64_tr_b16 v[212:213], v14 offset:2048
    ds_read_b64_tr_b16 v[214:215], v14 offset:2560
    v_mfma_f32_32x32x16_bf16 v[160:175], v[228:231], v[232:235], v[160:175]
    ds_read_b128 v[216:219], v6 offset:24576
    ds_read_b128 v[220:223], v6 offset:28672
    v_mfma_f32_32x32x16_bf16 v[176:191], v[228:231], v[236:239], v[176:191]
    s_waitcnt lgkmcnt(6)
    v_mfma_f32_32x32x16_bf16 v[128:143], v[192:195], v[200:203], v[128:143]
    ds_read_b64_tr_b16 v[224:225], v13 offset:4096
    ds_read_b64_tr_b16 v[226:227], v13 offset:4608
    v_mfma_f32_32x32x16_bf16 v[144:159], v[192:195], v[204:207], v[144:159]
    ds_read_b64_tr_b16 v[228:229], v14 offset:4096
    ds_read_b64_tr_b16 v[230:231], v14 offset:4608
    v_mfma_f32_32x32x16_bf16 v[160:175], v[196:199], v[200:203], v[160:175]
    ds_read_b128 v[232:235], v7 offset:24576
    ds_read_b128 v[236:239], v7 offset:28672
    v_mfma_f32_32x32x16_bf16 v[176:191], v[196:199], v[204:207], v[176:191]
    s_waitcnt lgkmcnt(6)
    v_mfma_f32_32x32x16_bf16 v[128:143], v[208:211], v[216:219], v[128:143]
    ds_read_b64_tr_b16 v[192:193], v13 offset:6144
    ds_read_b64_tr_b16 v[194:195], v13 offset:6656
    v_mfma_f32_32x32x16_bf16 v[144:159], v[208:211], v[220:223], v[144:159]
    ds_read_b64_tr_b16 v[196:197], v14 offset:6144
    ds_read_b64_tr_b16 v[198:199], v14 offset:6656
    v_mfma_f32_32x32x16_bf16 v[160:175], v[212:215], v[216:219], v[160:175]
    ds_read_b128 v[200:203], v8 offset:24576
    ds_read_b128 v[204:207], v8 offset:28672
    v_mfma_f32_32x32x16_bf16 v[176:191], v[212:215], v[220:223], v[176:191]
    s_waitcnt lgkmcnt(6)
    v_mfma_f32_32x32x16_bf16 v[128:143], v[224:227], v[232:235], v[128:143]
    v_mfma_f32_32x32x16_bf16 v[144:159], v[224:227], v[236:239], v[144:159]
    s_waitcnt lgkmcnt(0)
    s_barrier
    ds_read_b64_tr_b16 v[208:209], v13 offset:8192
    ds_read_b64_tr_b16 v[210:211], v13 offset:8704
    v_mfma_f32_32x32x16_bf16 v[160:175], v[228:231], v[232:235], v[160:175]
    ds_read_b64_tr_b16 v[212:213], v14 offset:8192
    ds_read_b64_tr_b16 v[214:215], v14 offset:8704
    v_mfma_f32_32x32x16_bf16 v[176:191], v[228:231], v[236:239], v[176:191]
    ds_read_b128 v[216:219], v5 offset:32768
    ds_read_b128 v[220:223], v5 offset:36864
    v_mfma_f32_32x32x16_bf16 v[128:143], v[192:195], v[200:203], v[128:143]
    ds_read_b64_tr_b16 v[224:225], v13 offset:10240
    ds_read_b64_tr_b16 v[226:227], v13 offset:10752
    v_mfma_f32_32x32x16_bf16 v[144:159], v[192:195], v[204:207], v[144:159]
    ds_read_b64_tr_b16 v[228:229], v14 offset:10240
    ds_read_b64_tr_b16 v[230:231], v14 offset:10752
    v_mfma_f32_32x32x16_bf16 v[160:175], v[196:199], v[200:203], v[160:175]
    ds_read_b128 v[232:235], v6 offset:32768
    ds_read_b128 v[236:239], v6 offset:36864
    v_mfma_f32_32x32x16_bf16 v[176:191], v[196:199], v[204:207], v[176:191]
    s_waitcnt lgkmcnt(6)
    v_mfma_f32_32x32x16_bf16 v[128:143], v[208:211], v[216:219], v[128:143]
    ds_read_b64_tr_b16 v[192:193], v13 offset:12288
    ds_read_b64_tr_b16 v[194:195], v13 offset:12800
    v_mfma_f32_32x32x16_bf16 v[144:159], v[208:211], v[220:223], v[144:159]
    ds_read_b64_tr_b16 v[196:197], v14 offset:12288
    ds_read_b64_tr_b16 v[198:199], v14 offset:12800
    v_mfma_f32_32x32x16_bf16 v[160:175], v[212:215], v[216:219], v[160:175]
    ds_read_b128 v[200:203], v7 offset:32768
    ds_read_b128 v[204:207], v7 offset:36864
    v_mfma_f32_32x32x16_bf16 v[176:191], v[212:215], v[220:223], v[176:191]
    s_waitcnt lgkmcnt(6)
    v_mfma_f32_32x32x16_bf16 v[128:143], v[224:227], v[232:235], v[128:143]
    ds_read_b64_tr_b16 v[208:209], v13 offset:14336
    ds_read_b64_tr_b16 v[210:211], v13 offset:14848
    v_mfma_f32_32x32x16_bf16 v[144:159], v[224:227], v[236:239], v[144:159]
    ds_read_b64_tr_b16 v[212:213], v14 offset:14336
    ds_read_b64_tr_b16 v[214:215], v14 offset:14848
    v_mfma_f32_32x32x16_bf16 v[160:175], v[228:231], v[232:235], v[160:175]
    ds_read_b128 v[216:219], v8 offset:32768
    ds_read_b128 v[220:223], v8 offset:36864
    v_mfma_f32_32x32x16_bf16 v[176:191], v[228:231], v[236:239], v[176:191]
    s_waitcnt lgkmcnt(6)
    v_mfma_f32_32x32x16_bf16 v[128:143], v[192:195], v[200:203], v[128:143]
    v_mfma_f32_32x32x16_bf16 v[144:159], v[192:195], v[204:207], v[144:159]
    s_waitcnt lgkmcnt(0)
    s_barrier
    ds_read_b64_tr_b16 v[224:225], v13 offset:16384
    ds_read_b64_tr_b16 v[226:227], v13 offset:16896
    v_mfma_f32_32x32x16_bf16 v[160:175], v[196:199], v[200:203], v[160:175]
    ds_read_b64_tr_b16 v[228:229], v14 offset:16384
    ds_read_b64_tr_b16 v[230:231], v14 offset:16896
    v_mfma_f32_32x32x16_bf16 v[176:191], v[196:199], v[204:207], v[176:191]
    ds_read_b128 v[232:235], v5 offset:40960
    ds_read_b128 v[236:239], v5 offset:45056
    v_mfma_f32_32x32x16_bf16 v[128:143], v[208:211], v[216:219], v[128:143]
    ds_read_b64_tr_b16 v[192:193], v13 offset:18432
    ds_read_b64_tr_b16 v[194:195], v13 offset:18944
    v_mfma_f32_32x32x16_bf16 v[144:159], v[208:211], v[220:223], v[144:159]
    ds_read_b64_tr_b16 v[196:197], v14 offset:18432
    ds_read_b64_tr_b16 v[198:199], v14 offset:18944
    v_mfma_f32_32x32x16_bf16 v[160:175], v[212:215], v[216:219], v[160:175]
    ds_read_b128 v[200:203], v6 offset:40960
    ds_read_b128 v[204:207], v6 offset:45056
    v_mfma_f32_32x32x16_bf16 v[176:191], v[212:215], v[220:223], v[176:191]
    s_waitcnt lgkmcnt(6)
    v_mfma_f32_32x32x16_bf16 v[128:143], v[224:227], v[232:235], v[128:143]
    ds_read_b64_tr_b16 v[208:209], v13 offset:20480
    ds_read_b64_tr_b16 v[210:211], v13 offset:20992
    v_mfma_f32_32x32x16_bf16 v[144:159], v[224:227], v[236:239], v[144:159]
    ds_read_b64_tr_b16 v[212:213], v14 offset:20480
    ds_read_b64_tr_b16 v[214:215], v14 offset:20992
    v_mfma_f32_32x32x16_bf16 v[160:175], v[228:231], v[232:235], v[160:175]
    ds_read_b128 v[216:219], v7 offset:40960
    ds_read_b128 v[220:223], v7 offset:45056
    v_mfma_f32_32x32x16_bf16 v[176:191], v[228:231], v[236:239], v[176:191]
    s_waitcnt lgkmcnt(6)
    v_mfma_f32_32x32x16_bf16 v[128:143], v[192:195], v[200:203], v[128:143]
    ds_read_b64_tr_b16 v[224:225], v13 offset:22528
    ds_read_b64_tr_b16 v[226:227], v13 offset:23040
    v_mfma_f32_32x32x16_bf16 v[144:159], v[192:195], v[204:207], v[144:159]
    ds_read_b64_tr_b16 v[228:229], v14 offset:22528
    ds_read_b64_tr_b16 v[230:231], v14 offset:23040
    v_mfma_f32_32x32x16_bf16 v[160:175], v[196:199], v[200:203], v[160:175]
    ds_read_b128 v[232:235], v8 offset:40960
    ds_read_b128 v[236:239], v8 offset:45056
    v_mfma_f32_32x32x16_bf16 v[176:191], v[196:199], v[204:207], v[176:191]
    s_waitcnt lgkmcnt(6)
    v_mfma_f32_32x32x16_bf16 v[128:143], v[208:211], v[216:219], v[128:143]
    v_mfma_f32_32x32x16_bf16 v[144:159], v[208:211], v[220:223], v[144:159]
    s_waitcnt lgkmcnt(0)
    s_barrier
    ds_read_b64_tr_b16 v[192:193], v13 offset:0
    ds_read_b64_tr_b16 v[194:195], v13 offset:512
    v_mfma_f32_32x32x16_bf16 v[160:175], v[212:215], v[216:219], v[160:175]
    ds_read_b64_tr_b16 v[196:197], v14 offset:0
    ds_read_b64_tr_b16 v[198:199], v14 offset:512
    v_mfma_f32_32x32x16_bf16 v[176:191], v[212:215], v[220:223], v[176:191]
    ds_read_b128 v[200:203], v5 offset:49152
    ds_read_b128 v[204:207], v5 offset:53248
    v_mfma_f32_32x32x16_bf16 v[128:143], v[224:227], v[232:235], v[128:143]
    ds_read_b64_tr_b16 v[208:209], v13 offset:2048
    ds_read_b64_tr_b16 v[210:211], v13 offset:2560
    v_mfma_f32_32x32x16_bf16 v[144:159], v[224:227], v[236:239], v[144:159]
    ds_read_b64_tr_b16 v[212:213], v14 offset:2048
    ds_read_b64_tr_b16 v[214:215], v14 offset:2560
    v_mfma_f32_32x32x16_bf16 v[160:175], v[228:231], v[232:235], v[160:175]
    ds_read_b128 v[216:219], v6 offset:49152
    ds_read_b128 v[220:223], v6 offset:53248
    v_mfma_f32_32x32x16_bf16 v[176:191], v[228:231], v[236:239], v[176:191]
    s_waitcnt lgkmcnt(6)
    v_mfma_f32_32x32x16_bf16 v[128:143], v[192:195], v[200:203], v[128:143]
    ds_read_b64_tr_b16 v[224:225], v13 offset:4096
    ds_read_b64_tr_b16 v[226:227], v13 offset:4608
    v_mfma_f32_32x32x16_bf16 v[144:159], v[192:195], v[204:207], v[144:159]
    ds_read_b64_tr_b16 v[228:229], v14 offset:4096
    ds_read_b64_tr_b16 v[230:231], v14 offset:4608
    v_mfma_f32_32x32x16_bf16 v[160:175], v[196:199], v[200:203], v[160:175]
    ds_read_b128 v[232:235], v7 offset:49152
    ds_read_b128 v[236:239], v7 offset:53248
    v_mfma_f32_32x32x16_bf16 v[176:191], v[196:199], v[204:207], v[176:191]
    s_waitcnt lgkmcnt(6)
    v_mfma_f32_32x32x16_bf16 v[128:143], v[208:211], v[216:219], v[128:143]
    ds_read_b64_tr_b16 v[192:193], v13 offset:6144
    ds_read_b64_tr_b16 v[194:195], v13 offset:6656
    v_mfma_f32_32x32x16_bf16 v[144:159], v[208:211], v[220:223], v[144:159]
    ds_read_b64_tr_b16 v[196:197], v14 offset:6144
    ds_read_b64_tr_b16 v[198:199], v14 offset:6656
    v_mfma_f32_32x32x16_bf16 v[160:175], v[212:215], v[216:219], v[160:175]
    ds_read_b128 v[200:203], v8 offset:49152
    ds_read_b128 v[204:207], v8 offset:53248
    v_mfma_f32_32x32x16_bf16 v[176:191], v[212:215], v[220:223], v[176:191]
    s_waitcnt lgkmcnt(6)
    v_mfma_f32_32x32x16_bf16 v[128:143], v[224:227], v[232:235], v[128:143]
    v_mfma_f32_32x32x16_bf16 v[144:159], v[224:227], v[236:239], v[144:159]
    v_mfma_f32_32x32x16_bf16 v[160:175], v[228:231], v[232:235], v[160:175]
    v_mfma_f32_32x32x16_bf16 v[176:191], v[228:231], v[236:239], v[176:191]
    s_waitcnt lgkmcnt(0)
    v_mfma_f32_32x32x16_bf16 v[128:143], v[192:195], v[200:203], v[128:143]
    v_mfma_f32_32x32x16_bf16 v[144:159], v[192:195], v[204:207], v[144:159]
    v_mfma_f32_32x32x16_bf16 v[160:175], v[196:199], v[200:203], v[160:175]
    v_mfma_f32_32x32x16_bf16 v[176:191], v[196:199], v[204:207], v[176:191]
    s_nop 8
    v_cvt_pk_bf16_f32 v64, v128, v129
    v_cvt_pk_bf16_f32 v65, v130, v131
    v_cvt_pk_bf16_f32 v66, v132, v133
    v_cvt_pk_bf16_f32 v67, v134, v135
    v_cvt_pk_bf16_f32 v68, v136, v137
    v_cvt_pk_bf16_f32 v69, v138, v139
    v_cvt_pk_bf16_f32 v70, v140, v141
    v_cvt_pk_bf16_f32 v71, v142, v143
    v_cvt_pk_bf16_f32 v72, v144, v145
    v_cvt_pk_bf16_f32 v73, v146, v147
    v_cvt_pk_bf16_f32 v74, v148, v149
    v_cvt_pk_bf16_f32 v75, v150, v151
    v_cvt_pk_bf16_f32 v76, v152, v153
    v_cvt_pk_bf16_f32 v77, v154, v155
    v_cvt_pk_bf16_f32 v78, v156, v157
    v_cvt_pk_bf16_f32 v79, v158, v159
    v_cvt_pk_bf16_f32 v80, v160, v161
    v_cvt_pk_bf16_f32 v81, v162, v163
    v_cvt_pk_bf16_f32 v82, v164, v165
    v_cvt_pk_bf16_f32 v83, v166, v167
    v_cvt_pk_bf16_f32 v84, v168, v169
    v_cvt_pk_bf16_f32 v85, v170, v171
    v_cvt_pk_bf16_f32 v86, v172, v173
    v_cvt_pk_bf16_f32 v87, v174, v175
    v_cvt_pk_bf16_f32 v88, v176, v177
    v_cvt_pk_bf16_f32 v89, v178, v179
    v_cvt_pk_bf16_f32 v90, v180, v181
    v_cvt_pk_bf16_f32 v91, v182, v183
    v_cvt_pk_bf16_f32 v92, v184, v185
    v_cvt_pk_bf16_f32 v93, v186, v187
    v_cvt_pk_bf16_f32 v94, v188, v189
    v_cvt_pk_bf16_f32 v95, v190, v191
    ds_write_b128 v2, v[64:67] offset:0
    ds_write_b128 v2, v[68:71] offset:1024
    ds_write_b128 v2, v[72:75] offset:16384
    ds_write_b128 v2, v[76:79] offset:17408
    ds_write_b128 v2, v[80:83] offset:2048
    ds_write_b128 v2, v[84:87] offset:3072
    ds_write_b128 v2, v[88:91] offset:18432
    ds_write_b128 v2, v[92:95] offset:19456
    s_waitcnt lgkmcnt(0)
    s_barrier
    ds_read_b128 v[64:67], v1 offset:0
    ds_read_b128 v[48:51], v9 offset:8192
    ds_read_b128 v[96:99], v1 offset:16384
    ds_read_b128 v[68:71], v1 offset:1024
    ds_read_b128 v[52:55], v10 offset:8192
    ds_read_b128 v[100:103], v1 offset:17408
    ds_read_b128 v[72:75], v1 offset:2048
    ds_read_b128 v[56:59], v11 offset:8192
    ds_read_b128 v[104:107], v1 offset:18432
    ds_read_b128 v[76:79], v1 offset:3072
    ds_read_b128 v[108:111], v1 offset:19456
    ds_read_b128 v[80:83], v1 offset:4096
    ds_read_b128 v[112:115], v1 offset:20480
    ds_read_b128 v[84:87], v1 offset:5120
    ds_read_b128 v[116:119], v1 offset:21504
    ds_read_b128 v[88:91], v1 offset:6144
    ds_read_b128 v[120:123], v1 offset:22528
    ds_read_b128 v[92:95], v1 offset:7168
    ds_read_b128 v[124:127], v1 offset:23552
    s_waitcnt lgkmcnt(15)
    v_mfma_f32_32x32x16_bf16 v[128:143], v[48:51], v[64:67], 0
    ds_read_b128 v[60:63], v12 offset:8192
    v_mfma_f32_32x32x16_bf16 v[144:159], v[48:51], v[96:99], 0
    s_waitcnt lgkmcnt(14)
    v_mfma_f32_32x32x16_bf16 v[128:143], v[52:55], v[68:71], v[128:143]
    ds_read_b128 v[48:51], v9 offset:12288
    v_mfma_f32_32x32x16_bf16 v[144:159], v[52:55], v[100:103], v[144:159]
    s_waitcnt lgkmcnt(12)
    v_mfma_f32_32x32x16_bf16 v[128:143], v[56:59], v[72:75], v[128:143]
    ds_read_b128 v[52:55], v10 offset:12288
    v_mfma_f32_32x32x16_bf16 v[144:159], v[56:59], v[104:107], v[144:159]
    s_waitcnt lgkmcnt(2)
    v_mfma_f32_32x32x16_bf16 v[128:143], v[60:63], v[76:79], v[128:143]
    ds_read_b128 v[56:59], v11 offset:12288
    v_mfma_f32_32x32x16_bf16 v[144:159], v[60:63], v[108:111], v[144:159]
    s_waitcnt lgkmcnt(2)
    v_mfma_f32_32x32x16_bf16 v[128:143], v[48:51], v[80:83], v[128:143]
    ds_read_b128 v[60:63], v12 offset:12288
    v_mfma_f32_32x32x16_bf16 v[144:159], v[48:51], v[112:115], v[144:159]
    s_waitcnt lgkmcnt(2)
    v_mfma_f32_32x32x16_bf16 v[128:143], v[52:55], v[84:87], v[128:143]
    v_mfma_f32_32x32x16_bf16 v[144:159], v[52:55], v[116:119], v[144:159]
    s_waitcnt lgkmcnt(0)
    s_barrier
    ds_read_b128 v[48:51], v9 offset:16384
    v_mfma_f32_32x32x16_bf16 v[128:143], v[56:59], v[88:91], v[128:143]
    ds_read_b128 v[52:55], v10 offset:16384
    v_mfma_f32_32x32x16_bf16 v[144:159], v[56:59], v[120:123], v[144:159]
    v_mfma_f32_32x32x16_bf16 v[128:143], v[60:63], v[92:95], v[128:143]
    ds_read_b128 v[56:59], v11 offset:16384
    v_mfma_f32_32x32x16_bf16 v[144:159], v[60:63], v[124:127], v[144:159]
    s_waitcnt lgkmcnt(2)
    v_mfma_f32_32x32x16_bf16 v[160:175], v[48:51], v[64:67], 0
    ds_read_b128 v[60:63], v12 offset:16384
    v_mfma_f32_32x32x16_bf16 v[176:191], v[48:51], v[96:99], 0
    s_waitcnt lgkmcnt(2)
    v_mfma_f32_32x32x16_bf16 v[160:175], v[52:55], v[68:71], v[160:175]
    ds_read_b128 v[48:51], v9 offset:20480
    v_mfma_f32_32x32x16_bf16 v[176:191], v[52:55], v[100:103], v[176:191]
    s_waitcnt lgkmcnt(2)
    v_mfma_f32_32x32x16_bf16 v[160:175], v[56:59], v[72:75], v[160:175]
    ds_read_b128 v[52:55], v10 offset:20480
    v_mfma_f32_32x32x16_bf16 v[176:191], v[56:59], v[104:107], v[176:191]
    s_waitcnt lgkmcnt(2)
    v_mfma_f32_32x32x16_bf16 v[160:175], v[60:63], v[76:79], v[160:175]
    ds_read_b128 v[56:59], v11 offset:20480
    v_mfma_f32_32x32x16_bf16 v[176:191], v[60:63], v[108:111], v[176:191]
    s_waitcnt lgkmcnt(2)
    v_mfma_f32_32x32x16_bf16 v[160:175], v[48:51], v[80:83], v[160:175]
    ds_read_b128 v[60:63], v12 offset:20480
    v_mfma_f32_32x32x16_bf16 v[176:191], v[48:51], v[112:115], v[176:191]
    s_waitcnt lgkmcnt(2)
    v_mfma_f32_32x32x16_bf16 v[160:175], v[52:55], v[84:87], v[160:175]
    v_mfma_f32_32x32x16_bf16 v[176:191], v[52:55], v[116:119], v[176:191]
    s_waitcnt lgkmcnt(0)
    s_barrier
    ds_read_b128 v[48:51], v9 offset:0
    v_mfma_f32_32x32x16_bf16 v[160:175], v[56:59], v[88:91], v[160:175]
    ds_read_b128 v[52:55], v10 offset:0
    v_mfma_f32_32x32x16_bf16 v[176:191], v[56:59], v[120:123], v[176:191]
    v_mfma_f32_32x32x16_bf16 v[160:175], v[60:63], v[92:95], v[160:175]
    ds_read_b128 v[56:59], v11 offset:0
    v_mfma_f32_32x32x16_bf16 v[176:191], v[60:63], v[124:127], v[176:191]
    s_waitcnt lgkmcnt(2)
    v_mfma_f32_32x32x16_bf16 v[192:207], v[48:51], v[64:67], 0
    ds_read_b128 v[60:63], v12 offset:0
    v_mfma_f32_32x32x16_bf16 v[208:223], v[48:51], v[96:99], 0
    s_waitcnt lgkmcnt(2)
    v_mfma_f32_32x32x16_bf16 v[192:207], v[52:55], v[68:71], v[192:207]
    ds_read_b128 v[48:51], v9 offset:4096
    v_mfma_f32_32x32x16_bf16 v[208:223], v[52:55], v[100:103], v[208:223]
    s_waitcnt lgkmcnt(2)
    v_mfma_f32_32x32x16_bf16 v[192:207], v[56:59], v[72:75], v[192:207]
    ds_read_b128 v[52:55], v10 offset:4096
    v_mfma_f32_32x32x16_bf16 v[208:223], v[56:59], v[104:107], v[208:223]
    s_waitcnt lgkmcnt(2)
    v_mfma_f32_32x32x16_bf16 v[192:207], v[60:63], v[76:79], v[192:207]
    ds_read_b128 v[56:59], v11 offset:4096
    v_mfma_f32_32x32x16_bf16 v[208:223], v[60:63], v[108:111], v[208:223]
    s_waitcnt lgkmcnt(2)
    v_mfma_f32_32x32x16_bf16 v[192:207], v[48:51], v[80:83], v[192:207]
    ds_read_b128 v[60:63], v12 offset:4096
    v_mfma_f32_32x32x16_bf16 v[208:223], v[48:51], v[112:115], v[208:223]
    s_waitcnt lgkmcnt(2)
    v_mfma_f32_32x32x16_bf16 v[192:207], v[52:55], v[84:87], v[192:207]
    v_mfma_f32_32x32x16_bf16 v[208:223], v[52:55], v[116:119], v[208:223]
    s_waitcnt lgkmcnt(0)
    s_barrier
    ds_read_b128 v[48:51], v9 offset:8192
    v_mfma_f32_32x32x16_bf16 v[192:207], v[56:59], v[88:91], v[192:207]
    ds_read_b128 v[52:55], v10 offset:8192
    v_mfma_f32_32x32x16_bf16 v[208:223], v[56:59], v[120:123], v[208:223]
    v_mfma_f32_32x32x16_bf16 v[192:207], v[60:63], v[92:95], v[192:207]
    ds_read_b128 v[56:59], v11 offset:8192
    v_mfma_f32_32x32x16_bf16 v[208:223], v[60:63], v[124:127], v[208:223]
    s_waitcnt lgkmcnt(2)
    v_mfma_f32_32x32x16_bf16 v[224:239], v[48:51], v[64:67], 0
    ds_read_b128 v[60:63], v12 offset:8192
    v_mfma_f32_32x32x16_bf16 v[240:255], v[48:51], v[96:99], 0
    ds_read_b128 v[64:67], v1 offset:8192
    ds_read_b128 v[96:99], v1 offset:24576
    s_waitcnt lgkmcnt(4)
    v_mfma_f32_32x32x16_bf16 v[224:239], v[52:55], v[68:71], v[224:239]
    ds_read_b128 v[48:51], v9 offset:12288
    v_mfma_f32_32x32x16_bf16 v[240:255], v[52:55], v[100:103], v[240:255]
    ds_read_b128 v[68:71], v1 offset:9216
    ds_read_b128 v[100:103], v1 offset:25600
    s_waitcnt lgkmcnt(6)
    v_mfma_f32_32x32x16_bf16 v[224:239], v[56:59], v[72:75], v[224:239]
    ds_read_b128 v[52:55], v10 offset:12288
    v_mfma_f32_32x32x16_bf16 v[240:255], v[56:59], v[104:107], v[240:255]
    ds_read_b128 v[72:75], v1 offset:10240
    ds_read_b128 v[104:107], v1 offset:26624
    s_waitcnt lgkmcnt(8)
    v_mfma_f32_32x32x16_bf16 v[224:239], v[60:63], v[76:79], v[224:239]
    ds_read_b128 v[56:59], v11 offset:12288
    v_mfma_f32_32x32x16_bf16 v[240:255], v[60:63], v[108:111], v[240:255]
    ds_read_b128 v[76:79], v1 offset:11264
    ds_read_b128 v[108:111], v1 offset:27648
    s_waitcnt lgkmcnt(8)
    v_mfma_f32_32x32x16_bf16 v[224:239], v[48:51], v[80:83], v[224:239]
    ds_read_b128 v[60:63], v12 offset:12288
    v_mfma_f32_32x32x16_bf16 v[240:255], v[48:51], v[112:115], v[240:255]
    ds_read_b128 v[80:83], v1 offset:12288
    ds_read_b128 v[112:115], v1 offset:28672
    s_waitcnt lgkmcnt(8)
    v_mfma_f32_32x32x16_bf16 v[224:239], v[52:55], v[84:87], v[224:239]
    v_mfma_f32_32x32x16_bf16 v[240:255], v[52:55], v[116:119], v[240:255]
    s_waitcnt lgkmcnt(2)
    s_barrier
    ds_read_b128 v[48:51], v9 offset:16384
    ds_read_b128 v[84:87], v1 offset:13312
    ds_read_b128 v[116:119], v1 offset:29696
    v_mfma_f32_32x32x16_bf16 v[224:239], v[56:59], v[88:91], v[224:239]
    ds_read_b128 v[52:55], v10 offset:16384
    v_mfma_f32_32x32x16_bf16 v[240:255], v[56:59], v[120:123], v[240:255]
    ds_read_b128 v[88:91], v1 offset:14336
    ds_read_b128 v[120:123], v1 offset:30720
    v_mfma_f32_32x32x16_bf16 v[224:239], v[60:63], v[92:95], v[224:239]
    ds_read_b128 v[56:59], v11 offset:16384
    v_mfma_f32_32x32x16_bf16 v[240:255], v[60:63], v[124:127], v[240:255]
    ds_read_b128 v[92:95], v1 offset:15360
    ds_read_b128 v[124:127], v1 offset:31744
    s_waitcnt lgkmcnt(8)
    v_mfma_f32_32x32x16_bf16 v[128:143], v[48:51], v[64:67], v[128:143]
    ds_read_b128 v[60:63], v12 offset:16384
    v_mfma_f32_32x32x16_bf16 v[144:159], v[48:51], v[96:99], v[144:159]
    s_waitcnt lgkmcnt(6)
    v_mfma_f32_32x32x16_bf16 v[128:143], v[52:55], v[68:71], v[128:143]
    ds_read_b128 v[48:51], v9 offset:20480
    v_mfma_f32_32x32x16_bf16 v[144:159], v[52:55], v[100:103], v[144:159]
    s_waitcnt lgkmcnt(4)
    v_mfma_f32_32x32x16_bf16 v[128:143], v[56:59], v[72:75], v[128:143]
    ds_read_b128 v[52:55], v10 offset:20480
    v_mfma_f32_32x32x16_bf16 v[144:159], v[56:59], v[104:107], v[144:159]
    s_waitcnt lgkmcnt(2)
    v_mfma_f32_32x32x16_bf16 v[128:143], v[60:63], v[76:79], v[128:143]
    ds_read_b128 v[56:59], v11 offset:20480
    v_mfma_f32_32x32x16_bf16 v[144:159], v[60:63], v[108:111], v[144:159]
    s_waitcnt lgkmcnt(2)
    v_mfma_f32_32x32x16_bf16 v[128:143], v[48:51], v[80:83], v[128:143]
    ds_read_b128 v[60:63], v12 offset:20480
    v_mfma_f32_32x32x16_bf16 v[144:159], v[48:51], v[112:115], v[144:159]
    s_waitcnt lgkmcnt(2)
    v_mfma_f32_32x32x16_bf16 v[128:143], v[52:55], v[84:87], v[128:143]
    v_mfma_f32_32x32x16_bf16 v[144:159], v[52:55], v[116:119], v[144:159]
    s_waitcnt lgkmcnt(0)
    s_barrier
    ds_read_b128 v[48:51], v9 offset:0
    v_mfma_f32_32x32x16_bf16 v[128:143], v[56:59], v[88:91], v[128:143]
    ds_read_b128 v[52:55], v10 offset:0
    v_mfma_f32_32x32x16_bf16 v[144:159], v[56:59], v[120:123], v[144:159]
    v_mfma_f32_32x32x16_bf16 v[128:143], v[60:63], v[92:95], v[128:143]
    ds_read_b128 v[56:59], v11 offset:0
    v_mfma_f32_32x32x16_bf16 v[144:159], v[60:63], v[124:127], v[144:159]
    s_waitcnt lgkmcnt(2)
    v_mfma_f32_32x32x16_bf16 v[160:175], v[48:51], v[64:67], v[160:175]
    ds_read_b128 v[60:63], v12 offset:0
    v_mfma_f32_32x32x16_bf16 v[176:191], v[48:51], v[96:99], v[176:191]
    s_waitcnt lgkmcnt(2)
    v_mfma_f32_32x32x16_bf16 v[160:175], v[52:55], v[68:71], v[160:175]
    ds_read_b128 v[48:51], v9 offset:4096
    v_mfma_f32_32x32x16_bf16 v[176:191], v[52:55], v[100:103], v[176:191]
    s_waitcnt lgkmcnt(2)
    v_mfma_f32_32x32x16_bf16 v[160:175], v[56:59], v[72:75], v[160:175]
    ds_read_b128 v[52:55], v10 offset:4096
    v_mfma_f32_32x32x16_bf16 v[176:191], v[56:59], v[104:107], v[176:191]
    s_waitcnt lgkmcnt(2)
    v_mfma_f32_32x32x16_bf16 v[160:175], v[60:63], v[76:79], v[160:175]
    ds_read_b128 v[56:59], v11 offset:4096
    v_max_f32 v44, v128, v129
    v_max3_f32 v44, v130, v131, v44
    v_mfma_f32_32x32x16_bf16 v[176:191], v[60:63], v[108:111], v[176:191]
    v_max3_f32 v44, v132, v133, v44
    v_max3_f32 v44, v134, v135, v44
    s_waitcnt lgkmcnt(2)
    v_mfma_f32_32x32x16_bf16 v[160:175], v[48:51], v[80:83], v[160:175]
    ds_read_b128 v[60:63], v12 offset:4096
    v_max3_f32 v44, v136, v137, v44
    v_mfma_f32_32x32x16_bf16 v[176:191], v[48:51], v[112:115], v[176:191]
    v_max3_f32 v44, v138, v139, v44
    v_max3_f32 v44, v140, v141, v44
    s_waitcnt lgkmcnt(2)
    v_mfma_f32_32x32x16_bf16 v[160:175], v[52:55], v[84:87], v[160:175]
    v_max3_f32 v44, v142, v143, v44
    v_mfma_f32_32x32x16_bf16 v[176:191], v[52:55], v[116:119], v[176:191]
    s_waitcnt lgkmcnt(0)
    s_barrier
    ds_read_b128 v[48:51], v9 offset:8192
    v_max_f32 v45, v144, v145
    v_max3_f32 v45, v146, v147, v45
    v_mfma_f32_32x32x16_bf16 v[160:175], v[56:59], v[88:91], v[160:175]
    ds_read_b128 v[52:55], v10 offset:8192
    v_max3_f32 v45, v148, v149, v45
    v_max3_f32 v45, v150, v151, v45
    v_mfma_f32_32x32x16_bf16 v[176:191], v[56:59], v[120:123], v[176:191]
    v_max3_f32 v45, v152, v153, v45
    v_mfma_f32_32x32x16_bf16 v[160:175], v[60:63], v[92:95], v[160:175]
    ds_read_b128 v[56:59], v11 offset:8192
    v_max3_f32 v45, v154, v155, v45
    v_max3_f32 v45, v156, v157, v45
    v_mfma_f32_32x32x16_bf16 v[176:191], v[60:63], v[124:127], v[176:191]
    v_max3_f32 v45, v158, v159, v45
    s_waitcnt lgkmcnt(2)
    v_mfma_f32_32x32x16_bf16 v[192:207], v[48:51], v[64:67], v[192:207]
    ds_read_b128 v[60:63], v12 offset:8192
    v_mfma_f32_32x32x16_bf16 v[208:223], v[48:51], v[96:99], v[208:223]
    s_waitcnt lgkmcnt(2)
    v_mfma_f32_32x32x16_bf16 v[192:207], v[52:55], v[68:71], v[192:207]
    ds_read_b128 v[48:51], v9 offset:12288
    v_mfma_f32_32x32x16_bf16 v[208:223], v[52:55], v[100:103], v[208:223]
    s_waitcnt lgkmcnt(2)
    v_mfma_f32_32x32x16_bf16 v[192:207], v[56:59], v[72:75], v[192:207]
    ds_read_b128 v[52:55], v10 offset:12288
    v_mfma_f32_32x32x16_bf16 v[208:223], v[56:59], v[104:107], v[208:223]
    s_waitcnt lgkmcnt(2)
    v_mfma_f32_32x32x16_bf16 v[192:207], v[60:63], v[76:79], v[192:207]
    ds_read_b128 v[56:59], v11 offset:12288
    v_max3_f32 v44, v160, v161, v44
    v_max3_f32 v44, v162, v163, v44
    v_mfma_f32_32x32x16_bf16 v[208:223], v[60:63], v[108:111], v[208:223]
    v_max3_f32 v44, v164, v165, v44
    v_max3_f32 v44, v166, v167, v44
    s_waitcnt lgkmcnt(2)
    v_mfma_f32_32x32x16_bf16 v[192:207], v[48:51], v[80:83], v[192:207]
    ds_read_b128 v[60:63], v12 offset:12288
    v_max3_f32 v44, v168, v169, v44
    v_mfma_f32_32x32x16_bf16 v[208:223], v[48:51], v[112:115], v[208:223]
    v_max3_f32 v44, v170, v171, v44
    v_max3_f32 v44, v172, v173, v44
    s_waitcnt lgkmcnt(2)
    v_mfma_f32_32x32x16_bf16 v[192:207], v[52:55], v[84:87], v[192:207]
    v_max3_f32 v44, v174, v175, v44
    v_mfma_f32_32x32x16_bf16 v[208:223], v[52:55], v[116:119], v[208:223]
    s_waitcnt lgkmcnt(0)
    s_barrier
    ds_read_b128 v[48:51], v9 offset:16384
    v_max3_f32 v45, v176, v177, v45
    v_max3_f32 v45, v178, v179, v45
    v_mfma_f32_32x32x16_bf16 v[192:207], v[56:59], v[88:91], v[192:207]
    ds_read_b128 v[52:55], v10 offset:16384
    v_max3_f32 v45, v180, v181, v45
    v_max3_f32 v45, v182, v183, v45
    v_mfma_f32_32x32x16_bf16 v[208:223], v[56:59], v[120:123], v[208:223]
    v_max3_f32 v45, v184, v185, v45
    v_mfma_f32_32x32x16_bf16 v[192:207], v[60:63], v[92:95], v[192:207]
    ds_read_b128 v[56:59], v11 offset:16384
    v_max3_f32 v45, v186, v187, v45
    v_max3_f32 v45, v188, v189, v45
    v_mfma_f32_32x32x16_bf16 v[208:223], v[60:63], v[124:127], v[208:223]
    v_max3_f32 v45, v190, v191, v45
    s_waitcnt lgkmcnt(2)
    v_mfma_f32_32x32x16_bf16 v[224:239], v[48:51], v[64:67], v[224:239]
    ds_read_b128 v[60:63], v12 offset:16384
    v_mfma_f32_32x32x16_bf16 v[240:255], v[48:51], v[96:99], v[240:255]
    s_waitcnt lgkmcnt(2)
    v_mfma_f32_32x32x16_bf16 v[224:239], v[52:55], v[68:71], v[224:239]
    ds_read_b128 v[48:51], v9 offset:20480
    v_mfma_f32_32x32x16_bf16 v[240:255], v[52:55], v[100:103], v[240:255]
    s_waitcnt lgkmcnt(2)
    v_mfma_f32_32x32x16_bf16 v[224:239], v[56:59], v[72:75], v[224:239]
    ds_read_b128 v[52:55], v10 offset:20480
    v_mfma_f32_32x32x16_bf16 v[240:255], v[56:59], v[104:107], v[240:255]
    s_waitcnt lgkmcnt(2)
    v_mfma_f32_32x32x16_bf16 v[224:239], v[60:63], v[76:79], v[224:239]
    ds_read_b128 v[56:59], v11 offset:20480
    v_max3_f32 v44, v192, v193, v44
    v_max3_f32 v44, v194, v195, v44
    v_mfma_f32_32x32x16_bf16 v[240:255], v[60:63], v[108:111], v[240:255]
    v_max3_f32 v44, v196, v197, v44
    v_max3_f32 v44, v198, v199, v44
    s_waitcnt lgkmcnt(2)
    v_mfma_f32_32x32x16_bf16 v[224:239], v[48:51], v[80:83], v[224:239]
    ds_read_b128 v[60:63], v12 offset:20480
    v_max3_f32 v44, v200, v201, v44
    v_mfma_f32_32x32x16_bf16 v[240:255], v[48:51], v[112:115], v[240:255]
    v_max3_f32 v44, v202, v203, v44
    v_max3_f32 v44, v204, v205, v44
    s_waitcnt lgkmcnt(2)
    v_mfma_f32_32x32x16_bf16 v[224:239], v[52:55], v[84:87], v[224:239]
    v_max3_f32 v44, v206, v207, v44
    v_mfma_f32_32x32x16_bf16 v[240:255], v[52:55], v[116:119], v[240:255]
    v_max3_f32 v45, v208, v209, v45
    v_max3_f32 v45, v210, v211, v45
    s_waitcnt lgkmcnt(1)
    v_mfma_f32_32x32x16_bf16 v[224:239], v[56:59], v[88:91], v[224:239]
    v_max3_f32 v45, v212, v213, v45
    v_max3_f32 v45, v214, v215, v45
    v_mfma_f32_32x32x16_bf16 v[240:255], v[56:59], v[120:123], v[240:255]
    v_max3_f32 v45, v216, v217, v45
    s_waitcnt lgkmcnt(0)
    v_mfma_f32_32x32x16_bf16 v[224:239], v[60:63], v[92:95], v[224:239]
    v_max3_f32 v45, v218, v219, v45
    v_max3_f32 v45, v220, v221, v45
    v_mfma_f32_32x32x16_bf16 v[240:255], v[60:63], v[124:127], v[240:255]
    v_max3_f32 v45, v222, v223, v45
    s_nop 7
    v_max3_f32 v44, v224, v225, v44
    v_max3_f32 v44, v226, v227, v44
    v_max3_f32 v44, v228, v229, v44
    v_max3_f32 v44, v230, v231, v44
    v_max3_f32 v44, v232, v233, v44
    v_max3_f32 v44, v234, v235, v44
    v_max3_f32 v44, v236, v237, v44
    v_max3_f32 v44, v238, v239, v44
    v_max3_f32 v45, v240, v241, v45
    v_max3_f32 v45, v242, v243, v45
    v_max3_f32 v45, v244, v245, v45
    v_max3_f32 v45, v246, v247, v45
    v_max3_f32 v45, v248, v249, v45
    v_max3_f32 v45, v250, v251, v45
    v_max3_f32 v45, v252, v253, v45
    v_max3_f32 v45, v254, v255, v45
    v_mov_b32 v24, v44
    v_mov_b32 v25, v45
    s_nop 0
    v_permlane32_swap_b32 v24, v44
    v_permlane32_swap_b32 v25, v45
    v_max_f32 v44, v24, v44
    ds_write_b32 v3, v44 offset:0
    v_max_f32 v45, v25, v45
    ds_write_b32 v3, v45 offset:512
    s_waitcnt lgkmcnt(0)
    s_barrier
    ds_read_b128 v[28:31], v4 offset:0
    ds_read_b128 v[32:35], v4 offset:512
    s_waitcnt lgkmcnt(1)
    v_max3_f32 v24, v28, v29, v30
    v_max_f32 v24, v24, v31
    v_mul_f32 v44, s49, v24
    s_waitcnt lgkmcnt(0)
    v_max3_f32 v24, v32, v33, v34
    v_max_f32 v24, v24, v35
    v_mul_f32 v45, s49, v24
    ds_read_b64_tr_b16 v[48:49], v15 offset:0
    ds_read_b64_tr_b16 v[50:51], v15 offset:1024
    ds_read_b64_tr_b16 v[52:53], v16 offset:0
    ds_read_b64_tr_b16 v[54:55], v16 offset:1024
    v_fma_f32 v128, v128, s49, -v44
    v_fma_f32 v129, v129, s49, -v44
    v_exp_f32 v128, v128
    v_fma_f32 v130, v130, s49, -v44
    v_exp_f32 v129, v129
    v_mov_b32 v46, v128
    v_fma_f32 v131, v131, s49, -v44
    v_exp_f32 v130, v130
    v_add_f32 v46, v46, v129
    v_cvt_pk_bf16_f32 v28, v128, v129
    v_fma_f32 v132, v132, s49, -v44
    v_exp_f32 v131, v131
    v_add_f32 v46, v46, v130
    v_fma_f32 v133, v133, s49, -v44
    v_exp_f32 v132, v132
    v_add_f32 v46, v46, v131
    v_cvt_pk_bf16_f32 v29, v130, v131
    v_fma_f32 v134, v134, s49, -v44
    v_exp_f32 v133, v133
    v_add_f32 v46, v46, v132
    v_fma_f32 v135, v135, s49, -v44
    v_exp_f32 v134, v134
    v_add_f32 v46, v46, v133
    v_cvt_pk_bf16_f32 v30, v132, v133
    v_fma_f32 v136, v136, s49, -v44
    v_exp_f32 v135, v135
    v_add_f32 v46, v46, v134
    v_fma_f32 v137, v137, s49, -v44
    v_exp_f32 v136, v136
    v_add_f32 v46, v46, v135
    v_cvt_pk_bf16_f32 v31, v134, v135
    v_fma_f32 v138, v138, s49, -v44
    v_exp_f32 v137, v137
    v_add_f32 v46, v46, v136
    v_fma_f32 v139, v139, s49, -v44
    v_exp_f32 v138, v138
    v_add_f32 v46, v46, v137
    v_cvt_pk_bf16_f32 v32, v136, v137
    v_fma_f32 v140, v140, s49, -v44
    v_exp_f32 v139, v139
    v_add_f32 v46, v46, v138
    v_fma_f32 v141, v141, s49, -v44
    v_exp_f32 v140, v140
    v_add_f32 v46, v46, v139
    v_cvt_pk_bf16_f32 v33, v138, v139
    v_fma_f32 v142, v142, s49, -v44
    v_exp_f32 v141, v141
    v_add_f32 v46, v46, v140
    v_fma_f32 v143, v143, s49, -v44
    v_exp_f32 v142, v142
    v_add_f32 v46, v46, v141
    v_cvt_pk_bf16_f32 v34, v140, v141
    v_exp_f32 v143, v143
    v_add_f32 v46, v46, v142
    v_add_f32 v46, v46, v143
    v_cvt_pk_bf16_f32 v35, v142, v143
    v_fma_f32 v144, v144, s49, -v45
    v_fma_f32 v145, v145, s49, -v45
    v_exp_f32 v144, v144
    v_fma_f32 v146, v146, s49, -v45
    v_exp_f32 v145, v145
    v_mov_b32 v47, v144
    v_fma_f32 v147, v147, s49, -v45
    v_exp_f32 v146, v146
    v_add_f32 v47, v47, v145
    v_cvt_pk_bf16_f32 v36, v144, v145
    v_fma_f32 v148, v148, s49, -v45
    v_exp_f32 v147, v147
    v_add_f32 v47, v47, v146
    v_fma_f32 v149, v149, s49, -v45
    v_exp_f32 v148, v148
    v_add_f32 v47, v47, v147
    v_cvt_pk_bf16_f32 v37, v146, v147
    v_fma_f32 v150, v150, s49, -v45
    v_exp_f32 v149, v149
    v_add_f32 v47, v47, v148
    v_fma_f32 v151, v151, s49, -v45
    v_exp_f32 v150, v150
    v_add_f32 v47, v47, v149
    v_cvt_pk_bf16_f32 v38, v148, v149
    v_fma_f32 v152, v152, s49, -v45
    v_exp_f32 v151, v151
    v_add_f32 v47, v47, v150
    v_fma_f32 v153, v153, s49, -v45
    v_exp_f32 v152, v152
    v_add_f32 v47, v47, v151
    v_cvt_pk_bf16_f32 v39, v150, v151
    v_fma_f32 v154, v154, s49, -v45
    v_exp_f32 v153, v153
    v_add_f32 v47, v47, v152
    v_fma_f32 v155, v155, s49, -v45
    v_exp_f32 v154, v154
    v_add_f32 v47, v47, v153
    v_cvt_pk_bf16_f32 v40, v152, v153
    v_fma_f32 v156, v156, s49, -v45
    v_exp_f32 v155, v155
    v_add_f32 v47, v47, v154
    v_fma_f32 v157, v157, s49, -v45
    v_exp_f32 v156, v156
    v_add_f32 v47, v47, v155
    v_cvt_pk_bf16_f32 v41, v154, v155
    v_fma_f32 v158, v158, s49, -v45
    v_exp_f32 v157, v157
    v_add_f32 v47, v47, v156
    v_fma_f32 v159, v159, s49, -v45
    v_exp_f32 v158, v158
    v_add_f32 v47, v47, v157
    v_cvt_pk_bf16_f32 v42, v156, v157
    v_exp_f32 v159, v159
    v_add_f32 v47, v47, v158
    v_add_f32 v47, v47, v159
    v_cvt_pk_bf16_f32 v43, v158, v159
    ds_read_b64_tr_b16 v[128:129], v15 offset:2048
    ds_read_b64_tr_b16 v[130:131], v15 offset:3072
    ds_read_b64_tr_b16 v[132:133], v16 offset:2048
    ds_read_b64_tr_b16 v[134:135], v16 offset:3072
    ds_write_b128 v2, v[28:31] offset:0
    ds_write_b128 v2, v[32:35] offset:1024
    ds_write_b128 v2, v[36:39] offset:2048
    ds_write_b128 v2, v[40:43] offset:3072
    s_waitcnt lgkmcnt(0)
    s_barrier
    ds_read_b128 v[56:59], v1 offset:0
    ds_read_b128 v[60:63], v1 offset:2048
    ds_read_b128 v[136:139], v1 offset:1024
    ds_read_b128 v[140:143], v1 offset:3072
    s_waitcnt lgkmcnt(2)
    v_mfma_f32_32x32x16_bf16 v[64:79], v[48:51], v[56:59], 0
    v_fma_f32 v160, v160, s49, -v44
    v_fma_f32 v161, v161, s49, -v44
    v_exp_f32 v160, v160
    v_fma_f32 v162, v162, s49, -v44
    v_exp_f32 v161, v161
    ds_read_b64_tr_b16 v[144:145], v15 offset:4096
    ds_read_b64_tr_b16 v[146:147], v15 offset:5120
    v_mfma_f32_32x32x16_bf16 v[80:95], v[48:51], v[60:63], 0
    v_add_f32 v46, v46, v160
    v_fma_f32 v163, v163, s49, -v44
    v_exp_f32 v162, v162
    v_add_f32 v46, v46, v161
    ds_read_b64_tr_b16 v[148:149], v16 offset:4096
    ds_read_b64_tr_b16 v[150:151], v16 offset:5120
    v_mfma_f32_32x32x16_bf16 v[96:111], v[52:55], v[56:59], 0
    v_cvt_pk_bf16_f32 v28, v160, v161
    v_fma_f32 v164, v164, s49, -v44
    v_exp_f32 v163, v163
    v_add_f32 v46, v46, v162
    ds_read_b128 v[152:155], v1 offset:4096
    ds_read_b128 v[156:159], v1 offset:6144
    v_mfma_f32_32x32x16_bf16 v[112:127], v[52:55], v[60:63], 0
    v_fma_f32 v165, v165, s49, -v44
    v_exp_f32 v164, v164
    v_add_f32 v46, v46, v163
    v_cvt_pk_bf16_f32 v29, v162, v163
    s_waitcnt lgkmcnt(6)
    v_mfma_f32_32x32x16_bf16 v[64:79], v[128:131], v[136:139], v[64:79]
    v_fma_f32 v166, v166, s49, -v44
    v_exp_f32 v165, v165
    v_add_f32 v46, v46, v164
    v_fma_f32 v167, v167, s49, -v44
    ds_read_b64_tr_b16 v[48:49], v15 offset:6144
    ds_read_b64_tr_b16 v[50:51], v15 offset:7168
    v_mfma_f32_32x32x16_bf16 v[80:95], v[128:131], v[140:143], v[80:95]
    v_exp_f32 v166, v166
    v_add_f32 v46, v46, v165
    v_cvt_pk_bf16_f32 v30, v164, v165
    v_fma_f32 v168, v168, s49, -v44
    ds_read_b64_tr_b16 v[52:53], v16 offset:6144
    ds_read_b64_tr_b16 v[54:55], v16 offset:7168
    v_mfma_f32_32x32x16_bf16 v[96:111], v[132:135], v[136:139], v[96:111]
    v_exp_f32 v167, v167
    v_add_f32 v46, v46, v166
    v_fma_f32 v169, v169, s49, -v44
    v_exp_f32 v168, v168
    v_add_f32 v46, v46, v167
    ds_read_b128 v[56:59], v1 offset:5120
    ds_read_b128 v[60:63], v1 offset:7168
    v_mfma_f32_32x32x16_bf16 v[112:127], v[132:135], v[140:143], v[112:127]
    v_cvt_pk_bf16_f32 v31, v166, v167
    v_fma_f32 v170, v170, s49, -v44
    v_exp_f32 v169, v169
    v_add_f32 v46, v46, v168
    s_waitcnt lgkmcnt(6)
    v_mfma_f32_32x32x16_bf16 v[64:79], v[144:147], v[152:155], v[64:79]
    v_fma_f32 v171, v171, s49, -v44
    v_exp_f32 v170, v170
    v_add_f32 v46, v46, v169
    v_cvt_pk_bf16_f32 v32, v168, v169
    v_mfma_f32_32x32x16_bf16 v[80:95], v[144:147], v[156:159], v[80:95]
    v_fma_f32 v172, v172, s49, -v44
    v_exp_f32 v171, v171
    v_add_f32 v46, v46, v170
    v_fma_f32 v173, v173, s49, -v44
    s_waitcnt lgkmcnt(2)
    s_barrier
    ds_read_b64_tr_b16 v[128:129], v15 offset:8192
    ds_read_b64_tr_b16 v[130:131], v15 offset:9216
    v_mfma_f32_32x32x16_bf16 v[96:111], v[148:151], v[152:155], v[96:111]
    v_exp_f32 v172, v172
    v_add_f32 v46, v46, v171
    v_cvt_pk_bf16_f32 v33, v170, v171
    v_fma_f32 v174, v174, s49, -v44
    ds_read_b64_tr_b16 v[132:133], v16 offset:8192
    ds_read_b64_tr_b16 v[134:135], v16 offset:9216
    v_mfma_f32_32x32x16_bf16 v[112:127], v[148:151], v[156:159], v[112:127]
    v_exp_f32 v173, v173
    v_add_f32 v46, v46, v172
    v_fma_f32 v175, v175, s49, -v44
    v_exp_f32 v174, v174
    ds_read_b128 v[136:139], v1 offset:8192
    ds_read_b128 v[140:143], v1 offset:10240
    s_waitcnt lgkmcnt(6)
    v_mfma_f32_32x32x16_bf16 v[64:79], v[48:51], v[56:59], v[64:79]
    v_add_f32 v46, v46, v173
    v_cvt_pk_bf16_f32 v34, v172, v173
    v_exp_f32 v175, v175
    v_add_f32 v46, v46, v174
    ds_read_b64_tr_b16 v[144:145], v15 offset:10240
    ds_read_b64_tr_b16 v[146:147], v15 offset:11264
    v_mfma_f32_32x32x16_bf16 v[80:95], v[48:51], v[60:63], v[80:95]
    v_add_f32 v46, v46, v175
    v_cvt_pk_bf16_f32 v35, v174, v175
    v_fma_f32 v176, v176, s49, -v45
    v_fma_f32 v177, v177, s49, -v45
    v_exp_f32 v176, v176
    ds_read_b64_tr_b16 v[148:149], v16 offset:10240
    ds_read_b64_tr_b16 v[150:151], v16 offset:11264
    v_mfma_f32_32x32x16_bf16 v[96:111], v[52:55], v[56:59], v[96:111]
    v_fma_f32 v178, v178, s49, -v45
    v_exp_f32 v177, v177
    v_add_f32 v47, v47, v176
    v_fma_f32 v179, v179, s49, -v45
    ds_read_b128 v[152:155], v1 offset:9216
    ds_read_b128 v[156:159], v1 offset:11264
    v_mfma_f32_32x32x16_bf16 v[112:127], v[52:55], v[60:63], v[112:127]
    v_exp_f32 v178, v178
    v_add_f32 v47, v47, v177
    v_cvt_pk_bf16_f32 v36, v176, v177
    v_fma_f32 v180, v180, s49, -v45
    s_waitcnt lgkmcnt(6)
    v_mfma_f32_32x32x16_bf16 v[64:79], v[128:131], v[136:139], v[64:79]
    v_exp_f32 v179, v179
    v_add_f32 v47, v47, v178
    v_fma_f32 v181, v181, s49, -v45
    v_exp_f32 v180, v180
    ds_read_b64_tr_b16 v[48:49], v15 offset:12288
    ds_read_b64_tr_b16 v[50:51], v15 offset:13312
    v_mfma_f32_32x32x16_bf16 v[80:95], v[128:131], v[140:143], v[80:95]
    v_add_f32 v47, v47, v179
    v_cvt_pk_bf16_f32 v37, v178, v179
    v_fma_f32 v182, v182, s49, -v45
    v_exp_f32 v181, v181
    ds_read_b64_tr_b16 v[52:53], v16 offset:12288
    ds_read_b64_tr_b16 v[54:55], v16 offset:13312
    v_mfma_f32_32x32x16_bf16 v[96:111], v[132:135], v[136:139], v[96:111]
    v_add_f32 v47, v47, v180
    v_fma_f32 v183, v183, s49, -v45
    v_exp_f32 v182, v182
    v_add_f32 v47, v47, v181
    ds_read_b128 v[56:59], v1 offset:12288
    ds_read_b128 v[60:63], v1 offset:14336
    v_mfma_f32_32x32x16_bf16 v[112:127], v[132:135], v[140:143], v[112:127]
    v_cvt_pk_bf16_f32 v38, v180, v181
    v_fma_f32 v184, v184, s49, -v45
    v_exp_f32 v183, v183
    v_add_f32 v47, v47, v182
    s_waitcnt lgkmcnt(6)
    v_mfma_f32_32x32x16_bf16 v[64:79], v[144:147], v[152:155], v[64:79]
    v_fma_f32 v185, v185, s49, -v45
    v_exp_f32 v184, v184
    v_add_f32 v47, v47, v183
    v_cvt_pk_bf16_f32 v39, v182, v183
    v_fma_f32 v186, v186, s49, -v45
    ds_read_b64_tr_b16 v[128:129], v15 offset:14336
    ds_read_b64_tr_b16 v[130:131], v15 offset:15360
    v_mfma_f32_32x32x16_bf16 v[80:95], v[144:147], v[156:159], v[80:95]
    v_exp_f32 v185, v185
    v_add_f32 v47, v47, v184
    v_fma_f32 v187, v187, s49, -v45
    v_exp_f32 v186, v186
    ds_read_b64_tr_b16 v[132:133], v16 offset:14336
    ds_read_b64_tr_b16 v[134:135], v16 offset:15360
    v_mfma_f32_32x32x16_bf16 v[96:111], v[148:151], v[152:155], v[96:111]
    v_add_f32 v47, v47, v185
    v_cvt_pk_bf16_f32 v40, v184, v185
    v_fma_f32 v188, v188, s49, -v45
    v_exp_f32 v187, v187
    ds_read_b128 v[136:139], v1 offset:13312
    ds_read_b128 v[140:143], v1 offset:15360
    v_mfma_f32_32x32x16_bf16 v[112:127], v[148:151], v[156:159], v[112:127]
    v_add_f32 v47, v47, v186
    v_fma_f32 v189, v189, s49, -v45
    v_exp_f32 v188, v188
    v_add_f32 v47, v47, v187
    s_waitcnt lgkmcnt(6)
    v_mfma_f32_32x32x16_bf16 v[64:79], v[48:51], v[56:59], v[64:79]
    v_cvt_pk_bf16_f32 v41, v186, v187
    v_fma_f32 v190, v190, s49, -v45
    v_exp_f32 v189, v189
    v_add_f32 v47, v47, v188
    v_mfma_f32_32x32x16_bf16 v[80:95], v[48:51], v[60:63], v[80:95]
    v_fma_f32 v191, v191, s49, -v45
    v_exp_f32 v190, v190
    v_add_f32 v47, v47, v189
    v_cvt_pk_bf16_f32 v42, v188, v189
    v_mfma_f32_32x32x16_bf16 v[96:111], v[52:55], v[56:59], v[96:111]
    v_exp_f32 v191, v191
    v_add_f32 v47, v47, v190
    v_add_f32 v47, v47, v191
    v_cvt_pk_bf16_f32 v43, v190, v191
    v_mfma_f32_32x32x16_bf16 v[112:127], v[52:55], v[60:63], v[112:127]
    ds_write_b128 v2, v[28:31] offset:16384
    ds_write_b128 v2, v[32:35] offset:17408
    ds_write_b128 v2, v[36:39] offset:18432
    ds_write_b128 v2, v[40:43] offset:19456
    s_waitcnt lgkmcnt(0)
    s_barrier
    v_mfma_f32_32x32x16_bf16 v[64:79], v[128:131], v[136:139], v[64:79]
    ds_read_b64_tr_b16 v[144:145], v15 offset:16384
    ds_read_b64_tr_b16 v[146:147], v15 offset:17408
    ds_read_b64_tr_b16 v[148:149], v16 offset:16384
    v_mfma_f32_32x32x16_bf16 v[80:95], v[128:131], v[140:143], v[80:95]
    ds_read_b64_tr_b16 v[150:151], v16 offset:17408
    ds_read_b128 v[152:155], v1 offset:16384
    ds_read_b128 v[156:159], v1 offset:18432
    v_mfma_f32_32x32x16_bf16 v[96:111], v[132:135], v[136:139], v[96:111]
    ds_read_b64_tr_b16 v[48:49], v15 offset:18432
    ds_read_b64_tr_b16 v[50:51], v15 offset:19456
    ds_read_b64_tr_b16 v[52:53], v16 offset:18432
    v_mfma_f32_32x32x16_bf16 v[112:127], v[132:135], v[140:143], v[112:127]
    ds_read_b64_tr_b16 v[54:55], v16 offset:19456
    ds_read_b128 v[56:59], v1 offset:17408
    ds_read_b128 v[60:63], v1 offset:19456
    s_waitcnt lgkmcnt(6)
    v_mfma_f32_32x32x16_bf16 v[64:79], v[144:147], v[152:155], v[64:79]
    v_fma_f32 v192, v192, s49, -v44
    v_fma_f32 v193, v193, s49, -v44
    v_exp_f32 v192, v192
    v_fma_f32 v194, v194, s49, -v44
    v_exp_f32 v193, v193
    ds_read_b64_tr_b16 v[128:129], v15 offset:20480
    ds_read_b64_tr_b16 v[130:131], v15 offset:21504
    v_mfma_f32_32x32x16_bf16 v[80:95], v[144:147], v[156:159], v[80:95]
    v_add_f32 v46, v46, v192
    v_fma_f32 v195, v195, s49, -v44
    v_exp_f32 v194, v194
    v_add_f32 v46, v46, v193
    ds_read_b64_tr_b16 v[132:133], v16 offset:20480
    ds_read_b64_tr_b16 v[134:135], v16 offset:21504
    v_mfma_f32_32x32x16_bf16 v[96:111], v[148:151], v[152:155], v[96:111]
    v_cvt_pk_bf16_f32 v28, v192, v193
    v_fma_f32 v196, v196, s49, -v44
    v_exp_f32 v195, v195
    v_add_f32 v46, v46, v194
    ds_read_b128 v[136:139], v1 offset:20480
    ds_read_b128 v[140:143], v1 offset:22528
    v_mfma_f32_32x32x16_bf16 v[112:127], v[148:151], v[156:159], v[112:127]
    v_fma_f32 v197, v197, s49, -v44
    v_exp_f32 v196, v196
    v_add_f32 v46, v46, v195
    v_cvt_pk_bf16_f32 v29, v194, v195
    s_waitcnt lgkmcnt(6)
    v_mfma_f32_32x32x16_bf16 v[64:79], v[48:51], v[56:59], v[64:79]
    v_fma_f32 v198, v198, s49, -v44
    v_exp_f32 v197, v197
    v_add_f32 v46, v46, v196
    v_fma_f32 v199, v199, s49, -v44
    ds_read_b64_tr_b16 v[144:145], v15 offset:22528
    ds_read_b64_tr_b16 v[146:147], v15 offset:23552
    v_mfma_f32_32x32x16_bf16 v[80:95], v[48:51], v[60:63], v[80:95]
    v_exp_f32 v198, v198
    v_add_f32 v46, v46, v197
    v_cvt_pk_bf16_f32 v30, v196, v197
    v_fma_f32 v200, v200, s49, -v44
    ds_read_b64_tr_b16 v[148:149], v16 offset:22528
    ds_read_b64_tr_b16 v[150:151], v16 offset:23552
    v_mfma_f32_32x32x16_bf16 v[96:111], v[52:55], v[56:59], v[96:111]
    v_exp_f32 v199, v199
    v_add_f32 v46, v46, v198
    v_fma_f32 v201, v201, s49, -v44
    v_exp_f32 v200, v200
    v_add_f32 v46, v46, v199
    ds_read_b128 v[152:155], v1 offset:21504
    ds_read_b128 v[156:159], v1 offset:23552
    v_mfma_f32_32x32x16_bf16 v[112:127], v[52:55], v[60:63], v[112:127]
    v_cvt_pk_bf16_f32 v31, v198, v199
    v_fma_f32 v202, v202, s49, -v44
    v_exp_f32 v201, v201
    v_add_f32 v46, v46, v200
    s_waitcnt lgkmcnt(6)
    v_mfma_f32_32x32x16_bf16 v[64:79], v[128:131], v[136:139], v[64:79]
    v_fma_f32 v203, v203, s49, -v44
    v_exp_f32 v202, v202
    v_add_f32 v46, v46, v201
    v_cvt_pk_bf16_f32 v32, v200, v201
    v_mfma_f32_32x32x16_bf16 v[80:95], v[128:131], v[140:143], v[80:95]
    v_fma_f32 v204, v204, s49, -v44
    v_exp_f32 v203, v203
    v_add_f32 v46, v46, v202
    v_fma_f32 v205, v205, s49, -v44
    s_waitcnt lgkmcnt(2)
    s_barrier
    ds_read_b64_tr_b16 v[48:49], v15 offset:0
    ds_read_b64_tr_b16 v[50:51], v15 offset:1024
    v_mfma_f32_32x32x16_bf16 v[96:111], v[132:135], v[136:139], v[96:111]
    v_exp_f32 v204, v204
    v_add_f32 v46, v46, v203
    v_cvt_pk_bf16_f32 v33, v202, v203
    v_fma_f32 v206, v206, s49, -v44
    ds_read_b64_tr_b16 v[52:53], v16 offset:0
    ds_read_b64_tr_b16 v[54:55], v16 offset:1024
    v_mfma_f32_32x32x16_bf16 v[112:127], v[132:135], v[140:143], v[112:127]
    v_exp_f32 v205, v205
    v_add_f32 v46, v46, v204
    v_fma_f32 v207, v207, s49, -v44
    v_exp_f32 v206, v206
    ds_read_b128 v[56:59], v1 offset:24576
    ds_read_b128 v[60:63], v1 offset:26624
    s_waitcnt lgkmcnt(6)
    v_mfma_f32_32x32x16_bf16 v[64:79], v[144:147], v[152:155], v[64:79]
    v_add_f32 v46, v46, v205
    v_cvt_pk_bf16_f32 v34, v204, v205
    v_exp_f32 v207, v207
    v_add_f32 v46, v46, v206
    ds_read_b64_tr_b16 v[128:129], v15 offset:2048
    ds_read_b64_tr_b16 v[130:131], v15 offset:3072
    v_mfma_f32_32x32x16_bf16 v[80:95], v[144:147], v[156:159], v[80:95]
    v_add_f32 v46, v46, v207
    v_cvt_pk_bf16_f32 v35, v206, v207
    v_fma_f32 v208, v208, s49, -v45
    v_fma_f32 v209, v209, s49, -v45
    v_exp_f32 v208, v208
    ds_read_b64_tr_b16 v[132:133], v16 offset:2048
    ds_read_b64_tr_b16 v[134:135], v16 offset:3072
    v_mfma_f32_32x32x16_bf16 v[96:111], v[148:151], v[152:155], v[96:111]
    v_fma_f32 v210, v210, s49, -v45
    v_exp_f32 v209, v209
    v_add_f32 v47, v47, v208
    v_fma_f32 v211, v211, s49, -v45
    ds_read_b128 v[136:139], v1 offset:25600
    ds_read_b128 v[140:143], v1 offset:27648
    v_mfma_f32_32x32x16_bf16 v[112:127], v[148:151], v[156:159], v[112:127]
    v_exp_f32 v210, v210
    v_add_f32 v47, v47, v209
    v_cvt_pk_bf16_f32 v36, v208, v209
    v_fma_f32 v212, v212, s49, -v45
    s_waitcnt lgkmcnt(6)
    v_mfma_f32_32x32x16_bf16 v[64:79], v[48:51], v[56:59], v[64:79]
    v_exp_f32 v211, v211
    v_add_f32 v47, v47, v210
    v_fma_f32 v213, v213, s49, -v45
    v_exp_f32 v212, v212
    ds_read_b64_tr_b16 v[144:145], v15 offset:4096
    ds_read_b64_tr_b16 v[146:147], v15 offset:5120
    v_mfma_f32_32x32x16_bf16 v[80:95], v[48:51], v[60:63], v[80:95]
    v_add_f32 v47, v47, v211
    v_cvt_pk_bf16_f32 v37, v210, v211
    v_fma_f32 v214, v214, s49, -v45
    v_exp_f32 v213, v213
    ds_read_b64_tr_b16 v[148:149], v16 offset:4096
    ds_read_b64_tr_b16 v[150:151], v16 offset:5120
    v_mfma_f32_32x32x16_bf16 v[96:111], v[52:55], v[56:59], v[96:111]
    v_add_f32 v47, v47, v212
    v_fma_f32 v215, v215, s49, -v45
    v_exp_f32 v214, v214
    v_add_f32 v47, v47, v213
    ds_read_b128 v[152:155], v1 offset:28672
    ds_read_b128 v[156:159], v1 offset:30720
    v_mfma_f32_32x32x16_bf16 v[112:127], v[52:55], v[60:63], v[112:127]
    v_cvt_pk_bf16_f32 v38, v212, v213
    v_fma_f32 v216, v216, s49, -v45
    v_exp_f32 v215, v215
    v_add_f32 v47, v47, v214
    s_waitcnt lgkmcnt(6)
    v_mfma_f32_32x32x16_bf16 v[64:79], v[128:131], v[136:139], v[64:79]
    v_fma_f32 v217, v217, s49, -v45
    v_exp_f32 v216, v216
    v_add_f32 v47, v47, v215
    v_cvt_pk_bf16_f32 v39, v214, v215
    v_fma_f32 v218, v218, s49, -v45
    ds_read_b64_tr_b16 v[48:49], v15 offset:6144
    ds_read_b64_tr_b16 v[50:51], v15 offset:7168
    v_mfma_f32_32x32x16_bf16 v[80:95], v[128:131], v[140:143], v[80:95]
    v_exp_f32 v217, v217
    v_add_f32 v47, v47, v216
    v_fma_f32 v219, v219, s49, -v45
    v_exp_f32 v218, v218
    ds_read_b64_tr_b16 v[52:53], v16 offset:6144
    ds_read_b64_tr_b16 v[54:55], v16 offset:7168
    v_mfma_f32_32x32x16_bf16 v[96:111], v[132:135], v[136:139], v[96:111]
    v_add_f32 v47, v47, v217
    v_cvt_pk_bf16_f32 v40, v216, v217
    v_fma_f32 v220, v220, s49, -v45
    v_exp_f32 v219, v219
    ds_read_b128 v[56:59], v1 offset:29696
    ds_read_b128 v[60:63], v1 offset:31744
    v_mfma_f32_32x32x16_bf16 v[112:127], v[132:135], v[140:143], v[112:127]
    v_add_f32 v47, v47, v218
    v_fma_f32 v221, v221, s49, -v45
    v_exp_f32 v220, v220
    v_add_f32 v47, v47, v219
    s_waitcnt lgkmcnt(6)
    v_mfma_f32_32x32x16_bf16 v[64:79], v[144:147], v[152:155], v[64:79]
    v_cvt_pk_bf16_f32 v41, v218, v219
    v_fma_f32 v222, v222, s49, -v45
    v_exp_f32 v221, v221
    v_add_f32 v47, v47, v220
    v_mfma_f32_32x32x16_bf16 v[80:95], v[144:147], v[156:159], v[80:95]
    v_fma_f32 v223, v223, s49, -v45
    v_exp_f32 v222, v222
    v_add_f32 v47, v47, v221
    v_cvt_pk_bf16_f32 v42, v220, v221
    v_mfma_f32_32x32x16_bf16 v[96:111], v[148:151], v[152:155], v[96:111]
    v_exp_f32 v223, v223
    v_add_f32 v47, v47, v222
    v_add_f32 v47, v47, v223
    v_cvt_pk_bf16_f32 v43, v222, v223
    v_mfma_f32_32x32x16_bf16 v[112:127], v[148:151], v[156:159], v[112:127]
    ds_write_b128 v2, v[28:31] offset:32768
    ds_write_b128 v2, v[32:35] offset:33792
    ds_write_b128 v2, v[36:39] offset:34816
    ds_write_b128 v2, v[40:43] offset:35840
    s_waitcnt lgkmcnt(0)
    s_barrier
    v_mfma_f32_32x32x16_bf16 v[64:79], v[48:51], v[56:59], v[64:79]
    ds_read_b64_tr_b16 v[128:129], v15 offset:8192
    ds_read_b64_tr_b16 v[130:131], v15 offset:9216
    ds_read_b64_tr_b16 v[132:133], v16 offset:8192
    v_mfma_f32_32x32x16_bf16 v[80:95], v[48:51], v[60:63], v[80:95]
    ds_read_b64_tr_b16 v[134:135], v16 offset:9216
    ds_read_b128 v[136:139], v1 offset:32768
    ds_read_b128 v[140:143], v1 offset:34816
    v_mfma_f32_32x32x16_bf16 v[96:111], v[52:55], v[56:59], v[96:111]
    ds_read_b64_tr_b16 v[144:145], v15 offset:10240
    ds_read_b64_tr_b16 v[146:147], v15 offset:11264
    ds_read_b64_tr_b16 v[148:149], v16 offset:10240
    v_mfma_f32_32x32x16_bf16 v[112:127], v[52:55], v[60:63], v[112:127]
    ds_read_b64_tr_b16 v[150:151], v16 offset:11264
    ds_read_b128 v[152:155], v1 offset:33792
    ds_read_b128 v[156:159], v1 offset:35840
    s_waitcnt lgkmcnt(6)
    v_mfma_f32_32x32x16_bf16 v[64:79], v[128:131], v[136:139], v[64:79]
    v_fma_f32 v224, v224, s49, -v44
    v_fma_f32 v225, v225, s49, -v44
    v_exp_f32 v224, v224
    v_fma_f32 v226, v226, s49, -v44
    v_exp_f32 v225, v225
    ds_read_b64_tr_b16 v[48:49], v15 offset:12288
    ds_read_b64_tr_b16 v[50:51], v15 offset:13312
    v_mfma_f32_32x32x16_bf16 v[80:95], v[128:131], v[140:143], v[80:95]
    v_add_f32 v46, v46, v224
    v_fma_f32 v227, v227, s49, -v44
    v_exp_f32 v226, v226
    v_add_f32 v46, v46, v225
    ds_read_b64_tr_b16 v[52:53], v16 offset:12288
    ds_read_b64_tr_b16 v[54:55], v16 offset:13312
    v_mfma_f32_32x32x16_bf16 v[96:111], v[132:135], v[136:139], v[96:111]
    v_cvt_pk_bf16_f32 v28, v224, v225
    v_fma_f32 v228, v228, s49, -v44
    v_exp_f32 v227, v227
    v_add_f32 v46, v46, v226
    v_fma_f32 v229, v229, s49, -v44
    ds_read_b128 v[56:59], v1 offset:36864
    ds_read_b128 v[60:63], v1 offset:38912
    v_mfma_f32_32x32x16_bf16 v[112:127], v[132:135], v[140:143], v[112:127]
    v_exp_f32 v228, v228
    v_add_f32 v46, v46, v227
    v_cvt_pk_bf16_f32 v29, v226, v227
    v_fma_f32 v230, v230, s49, -v44
    s_waitcnt lgkmcnt(6)
    v_mfma_f32_32x32x16_bf16 v[64:79], v[144:147], v[152:155], v[64:79]
    v_exp_f32 v229, v229
    v_add_f32 v46, v46, v228
    v_fma_f32 v231, v231, s49, -v44
    v_exp_f32 v230, v230
    v_add_f32 v46, v46, v229
    ds_read_b64_tr_b16 v[128:129], v15 offset:14336
    ds_read_b64_tr_b16 v[130:131], v15 offset:15360
    v_mfma_f32_32x32x16_bf16 v[80:95], v[144:147], v[156:159], v[80:95]
    v_cvt_pk_bf16_f32 v30, v228, v229
    v_fma_f32 v232, v232, s49, -v44
    v_exp_f32 v231, v231
    v_add_f32 v46, v46, v230
    ds_read_b64_tr_b16 v[132:133], v16 offset:14336
    ds_read_b64_tr_b16 v[134:135], v16 offset:15360
    v_mfma_f32_32x32x16_bf16 v[96:111], v[148:151], v[152:155], v[96:111]
    v_fma_f32 v233, v233, s49, -v44
    v_exp_f32 v232, v232
    v_add_f32 v46, v46, v231
    v_cvt_pk_bf16_f32 v31, v230, v231
    ds_read_b128 v[136:139], v1 offset:37888
    ds_read_b128 v[140:143], v1 offset:39936
    v_mfma_f32_32x32x16_bf16 v[112:127], v[148:151], v[156:159], v[112:127]
    v_fma_f32 v234, v234, s49, -v44
    v_exp_f32 v233, v233
    v_add_f32 v46, v46, v232
    v_fma_f32 v235, v235, s49, -v44
    v_exp_f32 v234, v234
    s_waitcnt lgkmcnt(6)
    v_mfma_f32_32x32x16_bf16 v[64:79], v[48:51], v[56:59], v[64:79]
    v_add_f32 v46, v46, v233
    v_cvt_pk_bf16_f32 v32, v232, v233
    v_fma_f32 v236, v236, s49, -v44
    v_exp_f32 v235, v235
    v_mfma_f32_32x32x16_bf16 v[80:95], v[48:51], v[60:63], v[80:95]
    v_add_f32 v46, v46, v234
    v_fma_f32 v237, v237, s49, -v44
    v_exp_f32 v236, v236
    v_add_f32 v46, v46, v235
    v_cvt_pk_bf16_f32 v33, v234, v235
    s_waitcnt lgkmcnt(2)
    s_barrier
    ds_read_b64_tr_b16 v[144:145], v15 offset:16384
    ds_read_b64_tr_b16 v[146:147], v15 offset:17408
    v_mfma_f32_32x32x16_bf16 v[96:111], v[52:55], v[56:59], v[96:111]
    v_fma_f32 v238, v238, s49, -v44
    v_exp_f32 v237, v237
    v_add_f32 v46, v46, v236
    v_fma_f32 v239, v239, s49, -v44
    ds_read_b64_tr_b16 v[148:149], v16 offset:16384
    ds_read_b64_tr_b16 v[150:151], v16 offset:17408
    v_mfma_f32_32x32x16_bf16 v[112:127], v[52:55], v[60:63], v[112:127]
    v_exp_f32 v238, v238
    v_add_f32 v46, v46, v237
    v_cvt_pk_bf16_f32 v34, v236, v237
    v_exp_f32 v239, v239
    ds_read_b128 v[152:155], v1 offset:40960
    ds_read_b128 v[156:159], v1 offset:43008
    s_waitcnt lgkmcnt(6)
    v_mfma_f32_32x32x16_bf16 v[64:79], v[128:131], v[136:139], v[64:79]
    v_add_f32 v46, v46, v238
    v_add_f32 v46, v46, v239
    v_cvt_pk_bf16_f32 v35, v238, v239
    v_fma_f32 v240, v240, s49, -v45
    v_fma_f32 v241, v241, s49, -v45
    ds_read_b64_tr_b16 v[48:49], v15 offset:18432
    ds_read_b64_tr_b16 v[50:51], v15 offset:19456
    v_mfma_f32_32x32x16_bf16 v[80:95], v[128:131], v[140:143], v[80:95]
    v_exp_f32 v240, v240
    v_fma_f32 v242, v242, s49, -v45
    v_exp_f32 v241, v241
    v_add_f32 v47, v47, v240
    ds_read_b64_tr_b16 v[52:53], v16 offset:18432
    ds_read_b64_tr_b16 v[54:55], v16 offset:19456
    v_mfma_f32_32x32x16_bf16 v[96:111], v[132:135], v[136:139], v[96:111]
    v_fma_f32 v243, v243, s49, -v45
    v_exp_f32 v242, v242
    v_add_f32 v47, v47, v241
    v_cvt_pk_bf16_f32 v36, v240, v241
    v_fma_f32 v244, v244, s49, -v45
    ds_read_b128 v[56:59], v1 offset:41984
    ds_read_b128 v[60:63], v1 offset:44032
    v_mfma_f32_32x32x16_bf16 v[112:127], v[132:135], v[140:143], v[112:127]
    v_exp_f32 v243, v243
    v_add_f32 v47, v47, v242
    v_fma_f32 v245, v245, s49, -v45
    v_exp_f32 v244, v244
    s_waitcnt lgkmcnt(6)
    v_mfma_f32_32x32x16_bf16 v[64:79], v[144:147], v[152:155], v[64:79]
    v_add_f32 v47, v47, v243
    v_cvt_pk_bf16_f32 v37, v242, v243
    v_fma_f32 v246, v246, s49, -v45
    v_exp_f32 v245, v245
    ds_read_b64_tr_b16 v[128:129], v15 offset:20480
    ds_read_b64_tr_b16 v[130:131], v15 offset:21504
    v_mfma_f32_32x32x16_bf16 v[80:95], v[144:147], v[156:159], v[80:95]
    v_add_f32 v47, v47, v244
    v_fma_f32 v247, v247, s49, -v45
    v_exp_f32 v246, v246
    v_add_f32 v47, v47, v245
    v_cvt_pk_bf16_f32 v38, v244, v245
    ds_read_b64_tr_b16 v[132:133], v16 offset:20480
    ds_read_b64_tr_b16 v[134:135], v16 offset:21504
    v_mfma_f32_32x32x16_bf16 v[96:111], v[148:151], v[152:155], v[96:111]
    v_fma_f32 v248, v248, s49, -v45
    v_exp_f32 v247, v247
    v_add_f32 v47, v47, v246
    v_fma_f32 v249, v249, s49, -v45
    ds_read_b128 v[136:139], v1 offset:45056
    ds_read_b128 v[140:143], v1 offset:47104
    v_mfma_f32_32x32x16_bf16 v[112:127], v[148:151], v[156:159], v[112:127]
    v_exp_f32 v248, v248
    v_add_f32 v47, v47, v247
    v_cvt_pk_bf16_f32 v39, v246, v247
    v_fma_f32 v250, v250, s49, -v45
    v_exp_f32 v249, v249
    s_waitcnt lgkmcnt(6)
    v_mfma_f32_32x32x16_bf16 v[64:79], v[48:51], v[56:59], v[64:79]
    v_add_f32 v47, v47, v248
    v_fma_f32 v251, v251, s49, -v45
    v_exp_f32 v250, v250
    v_add_f32 v47, v47, v249
    ds_read_b64_tr_b16 v[144:145], v15 offset:22528
    ds_read_b64_tr_b16 v[146:147], v15 offset:23552
    v_mfma_f32_32x32x16_bf16 v[80:95], v[48:51], v[60:63], v[80:95]
    v_cvt_pk_bf16_f32 v40, v248, v249
    v_fma_f32 v252, v252, s49, -v45
    v_exp_f32 v251, v251
    v_add_f32 v47, v47, v250
    ds_read_b64_tr_b16 v[148:149], v16 offset:22528
    ds_read_b64_tr_b16 v[150:151], v16 offset:23552
    v_mfma_f32_32x32x16_bf16 v[96:111], v[52:55], v[56:59], v[96:111]
    v_fma_f32 v253, v253, s49, -v45
    v_exp_f32 v252, v252
    v_add_f32 v47, v47, v251
    v_cvt_pk_bf16_f32 v41, v250, v251
    v_fma_f32 v254, v254, s49, -v45
    ds_read_b128 v[152:155], v1 offset:46080
    ds_read_b128 v[156:159], v1 offset:48128
    v_mfma_f32_32x32x16_bf16 v[112:127], v[52:55], v[60:63], v[112:127]
    v_exp_f32 v253, v253
    v_add_f32 v47, v47, v252
    v_fma_f32 v255, v255, s49, -v45
    v_exp_f32 v254, v254
    s_waitcnt lgkmcnt(6)
    v_mfma_f32_32x32x16_bf16 v[64:79], v[128:131], v[136:139], v[64:79]
    v_add_f32 v47, v47, v253
    v_cvt_pk_bf16_f32 v42, v252, v253
    v_exp_f32 v255, v255
    v_add_f32 v47, v47, v254
    v_add_f32 v47, v47, v255
    v_mfma_f32_32x32x16_bf16 v[80:95], v[128:131], v[140:143], v[80:95]
    v_cvt_pk_bf16_f32 v43, v254, v255
    v_mov_b32 v24, v46
    v_mov_b32 v25, v47
    s_nop 0
    v_mfma_f32_32x32x16_bf16 v[96:111], v[132:135], v[136:139], v[96:111]
    v_permlane32_swap_b32 v24, v46
    v_permlane32_swap_b32 v25, v47
    v_add_f32 v46, v24, v46
    v_add_f32 v47, v25, v47
    v_mfma_f32_32x32x16_bf16 v[112:127], v[132:135], v[140:143], v[112:127]
    ds_write_b128 v2, v[28:31] offset:0
    ds_write_b128 v2, v[32:35] offset:1024
    ds_write_b128 v2, v[36:39] offset:2048
    ds_write_b128 v2, v[40:43] offset:3072
    ds_write_b32 v3, v46 offset:1024
    ds_write_b32 v3, v47 offset:1536
    s_waitcnt lgkmcnt(0)
    s_barrier
    v_mfma_f32_32x32x16_bf16 v[64:79], v[144:147], v[152:155], v[64:79]
    ds_read_b64_tr_b16 v[48:49], v15 offset:0
    ds_read_b64_tr_b16 v[50:51], v15 offset:1024
    ds_read_b64_tr_b16 v[52:53], v16 offset:0
    v_mfma_f32_32x32x16_bf16 v[80:95], v[144:147], v[156:159], v[80:95]
    ds_read_b64_tr_b16 v[54:55], v16 offset:1024
    ds_read_b128 v[56:59], v1 offset:0
    ds_read_b128 v[60:63], v1 offset:2048
    v_mfma_f32_32x32x16_bf16 v[96:111], v[148:151], v[152:155], v[96:111]
    ds_read_b64_tr_b16 v[128:129], v15 offset:2048
    ds_read_b64_tr_b16 v[130:131], v15 offset:3072
    ds_read_b64_tr_b16 v[132:133], v16 offset:2048
    v_mfma_f32_32x32x16_bf16 v[112:127], v[148:151], v[156:159], v[112:127]
    ds_read_b64_tr_b16 v[134:135], v16 offset:3072
    ds_read_b128 v[136:139], v1 offset:1024
    ds_read_b128 v[140:143], v1 offset:3072
    s_waitcnt lgkmcnt(6)
    v_mfma_f32_32x32x16_bf16 v[64:79], v[48:51], v[56:59], v[64:79]
    ds_read_b64_tr_b16 v[144:145], v15 offset:4096
    ds_read_b64_tr_b16 v[146:147], v15 offset:5120
    v_mfma_f32_32x32x16_bf16 v[80:95], v[48:51], v[60:63], v[80:95]
    ds_read_b64_tr_b16 v[148:149], v16 offset:4096
    ds_read_b64_tr_b16 v[150:151], v16 offset:5120
    v_mfma_f32_32x32x16_bf16 v[96:111], v[52:55], v[56:59], v[96:111]
    ds_read_b128 v[152:155], v1 offset:4096
    ds_read_b128 v[156:159], v1 offset:6144
    ds_read_b128 v[28:31], v22 offset:1024
    v_mfma_f32_32x32x16_bf16 v[112:127], v[52:55], v[60:63], v[112:127]
    s_waitcnt lgkmcnt(7)
    v_mfma_f32_32x32x16_bf16 v[64:79], v[128:131], v[136:139], v[64:79]
    ds_read_b64_tr_b16 v[48:49], v15 offset:6144
    ds_read_b64_tr_b16 v[50:51], v15 offset:7168
    s_waitcnt lgkmcnt(2)
    v_add_f32 v28, v28, v29
    v_mfma_f32_32x32x16_bf16 v[80:95], v[128:131], v[140:143], v[80:95]
    ds_read_b64_tr_b16 v[52:53], v16 offset:6144
    ds_read_b64_tr_b16 v[54:55], v16 offset:7168
    v_mfma_f32_32x32x16_bf16 v[96:111], v[132:135], v[136:139], v[96:111]
    ds_read_b128 v[56:59], v1 offset:5120
    ds_read_b128 v[60:63], v1 offset:7168
    v_add_f32 v30, v30, v31
    v_mfma_f32_32x32x16_bf16 v[112:127], v[132:135], v[140:143], v[112:127]
    v_mfma_f32_32x32x16_bf16 v[64:79], v[144:147], v[152:155], v[64:79]
    v_add_f32 v28, v28, v30
    v_mfma_f32_32x32x16_bf16 v[80:95], v[144:147], v[156:159], v[80:95]
    s_waitcnt lgkmcnt(2)
    s_barrier
    ds_read_b64_tr_b16 v[128:129], v15 offset:8192
    ds_read_b64_tr_b16 v[130:131], v15 offset:9216
    v_mfma_f32_32x32x16_bf16 v[96:111], v[148:151], v[152:155], v[96:111]
    ds_read_b64_tr_b16 v[132:133], v16 offset:8192
    ds_read_b64_tr_b16 v[134:135], v16 offset:9216
    v_rcp_f32 v44, v28
    v_mfma_f32_32x32x16_bf16 v[112:127], v[148:151], v[156:159], v[112:127]
    ds_read_b128 v[136:139], v1 offset:8192
    ds_read_b128 v[140:143], v1 offset:10240
    s_waitcnt lgkmcnt(6)
    v_mfma_f32_32x32x16_bf16 v[64:79], v[48:51], v[56:59], v[64:79]
    ds_read_b64_tr_b16 v[144:145], v15 offset:10240
    ds_read_b64_tr_b16 v[146:147], v15 offset:11264
    v_mfma_f32_32x32x16_bf16 v[80:95], v[48:51], v[60:63], v[80:95]
    ds_read_b64_tr_b16 v[148:149], v16 offset:10240
    ds_read_b64_tr_b16 v[150:151], v16 offset:11264
    v_mfma_f32_32x32x16_bf16 v[96:111], v[52:55], v[56:59], v[96:111]
    ds_read_b128 v[152:155], v1 offset:9216
    ds_read_b128 v[156:159], v1 offset:11264
    v_mfma_f32_32x32x16_bf16 v[112:127], v[52:55], v[60:63], v[112:127]
    s_waitcnt lgkmcnt(6)
    v_mfma_f32_32x32x16_bf16 v[64:79], v[128:131], v[136:139], v[64:79]
    ds_read_b64_tr_b16 v[48:49], v15 offset:12288
    ds_read_b64_tr_b16 v[50:51], v15 offset:13312
    s_barrier
    v_mfma_f32_32x32x16_bf16 v[80:95], v[128:131], v[140:143], v[80:95]
    ds_read_b64_tr_b16 v[52:53], v16 offset:12288
    ds_read_b64_tr_b16 v[54:55], v16 offset:13312
    v_mfma_f32_32x32x16_bf16 v[96:111], v[132:135], v[136:139], v[96:111]
    ds_read_b128 v[56:59], v1 offset:12288
    ds_read_b128 v[60:63], v1 offset:14336
    v_mfma_f32_32x32x16_bf16 v[112:127], v[132:135], v[140:143], v[112:127]
    s_waitcnt lgkmcnt(6)
    v_mfma_f32_32x32x16_bf16 v[64:79], v[144:147], v[152:155], v[64:79]
    ds_read_b64_tr_b16 v[128:129], v15 offset:14336
    ds_read_b64_tr_b16 v[130:131], v15 offset:15360
    v_mfma_f32_32x32x16_bf16 v[80:95], v[144:147], v[156:159], v[80:95]
    ds_read_b64_tr_b16 v[132:133], v16 offset:14336
    ds_read_b64_tr_b16 v[134:135], v16 offset:15360
    v_mfma_f32_32x32x16_bf16 v[96:111], v[148:151], v[152:155], v[96:111]
    ds_read_b128 v[136:139], v1 offset:13312
    ds_read_b128 v[140:143], v1 offset:15360
    v_mfma_f32_32x32x16_bf16 v[112:127], v[148:151], v[156:159], v[112:127]
    s_waitcnt lgkmcnt(6)
    v_mfma_f32_32x32x16_bf16 v[64:79], v[48:51], v[56:59], v[64:79]
    v_mfma_f32_32x32x16_bf16 v[80:95], v[48:51], v[60:63], v[80:95]
    v_mfma_f32_32x32x16_bf16 v[96:111], v[52:55], v[56:59], v[96:111]
    v_mfma_f32_32x32x16_bf16 v[112:127], v[52:55], v[60:63], v[112:127]
    s_waitcnt lgkmcnt(0)
    v_mfma_f32_32x32x16_bf16 v[64:79], v[128:131], v[136:139], v[64:79]
    v_mfma_f32_32x32x16_bf16 v[80:95], v[128:131], v[140:143], v[80:95]
    v_mfma_f32_32x32x16_bf16 v[96:111], v[132:135], v[136:139], v[96:111]
    v_mfma_f32_32x32x16_bf16 v[112:127], v[132:135], v[140:143], v[112:127]
    s_nop 8
    v_cvt_pk_bf16_f32 v224, v64, v65
    v_cvt_pk_bf16_f32 v225, v66, v67
    v_cvt_pk_bf16_f32 v226, v68, v69
    v_cvt_pk_bf16_f32 v227, v70, v71
    v_cvt_pk_bf16_f32 v228, v72, v73
    v_cvt_pk_bf16_f32 v229, v74, v75
    v_cvt_pk_bf16_f32 v230, v76, v77
    v_cvt_pk_bf16_f32 v231, v78, v79
    v_cvt_pk_bf16_f32 v232, v80, v81
    v_cvt_pk_bf16_f32 v233, v82, v83
    v_cvt_pk_bf16_f32 v234, v84, v85
    v_cvt_pk_bf16_f32 v235, v86, v87
    v_cvt_pk_bf16_f32 v236, v88, v89
    v_cvt_pk_bf16_f32 v237, v90, v91
    v_cvt_pk_bf16_f32 v238, v92, v93
    v_cvt_pk_bf16_f32 v239, v94, v95
    v_cvt_pk_bf16_f32 v240, v96, v97
    v_cvt_pk_bf16_f32 v241, v98, v99
    v_cvt_pk_bf16_f32 v242, v100, v101
    v_cvt_pk_bf16_f32 v243, v102, v103
    v_cvt_pk_bf16_f32 v244, v104, v105
    v_cvt_pk_bf16_f32 v245, v106, v107
    v_cvt_pk_bf16_f32 v246, v108, v109
    v_cvt_pk_bf16_f32 v247, v110, v111
    v_cvt_pk_bf16_f32 v248, v112, v113
    v_cvt_pk_bf16_f32 v249, v114, v115
    v_cvt_pk_bf16_f32 v250, v116, v117
    v_cvt_pk_bf16_f32 v251, v118, v119
    v_cvt_pk_bf16_f32 v252, v120, v121
    v_cvt_pk_bf16_f32 v253, v122, v123
    v_cvt_pk_bf16_f32 v254, v124, v125
    v_cvt_pk_bf16_f32 v255, v126, v127
    ds_write_b128 v2, v[224:227] offset:16384
    ds_write_b128 v2, v[228:231] offset:17408
    ds_write_b128 v2, v[232:235] offset:32768
    ds_write_b128 v2, v[236:239] offset:33792
    ds_write_b128 v2, v[240:243] offset:18432
    ds_write_b128 v2, v[244:247] offset:19456
    ds_write_b128 v2, v[248:251] offset:34816
    ds_write_b128 v2, v[252:255] offset:35840
    s_waitcnt lgkmcnt(0)
    s_barrier
    ds_read_b128 v[128:131], v20 offset:16384
    ds_read_b64_tr_b16 v[192:193], v17 offset:16384
    ds_read_b64_tr_b16 v[194:195], v17 offset:17408
    ds_read_b128 v[132:135], v20 offset:17408
    ds_read_b64_tr_b16 v[196:197], v17 offset:18432
    ds_read_b64_tr_b16 v[198:199], v17 offset:19456
    ds_read_b128 v[136:139], v20 offset:18432
    ds_read_b64_tr_b16 v[200:201], v17 offset:20480
    ds_read_b64_tr_b16 v[202:203], v17 offset:21504
    ds_read_b128 v[140:143], v20 offset:19456
    ds_read_b64_tr_b16 v[204:205], v17 offset:22528
    ds_read_b64_tr_b16 v[206:207], v17 offset:23552
    ds_read_b128 v[144:147], v20 offset:20480
    ds_read_b64_tr_b16 v[208:209], v17 offset:40960
    ds_read_b64_tr_b16 v[210:211], v17 offset:41984
    ds_read_b128 v[148:151], v20 offset:21504
    ds_read_b128 v[152:155], v20 offset:22528
    ds_read_b128 v[156:159], v20 offset:23552
    ds_read_b128 v[160:163], v20 offset:24576
    ds_read_b128 v[164:167], v20 offset:25600
    ds_read_b128 v[168:171], v20 offset:26624
    ds_read_b128 v[172:175], v20 offset:27648
    ds_read_b128 v[176:179], v20 offset:28672
    ds_read_b128 v[180:183], v20 offset:29696
    ds_read_b128 v[184:187], v20 offset:30720
    ds_read_b128 v[188:191], v20 offset:31744
    s_waitcnt lgkmcnt(15)
    v_mfma_f32_32x32x16_bf16 v[64:79], v[192:195], v[128:131], 0
    ds_read_b64_tr_b16 v[212:213], v17 offset:43008
    ds_read_b64_tr_b16 v[214:215], v17 offset:44032
    v_mfma_f32_32x32x16_bf16 v[64:79], v[196:199], v[132:135], v[64:79]
    ds_read_b64_tr_b16 v[216:217], v17 offset:45056
    ds_read_b64_tr_b16 v[218:219], v17 offset:46080
    v_mfma_f32_32x32x16_bf16 v[64:79], v[200:203], v[136:139], v[64:79]
    ds_read_b64_tr_b16 v[220:221], v17 offset:47104
    ds_read_b64_tr_b16 v[222:223], v17 offset:48128
    s_waitcnt lgkmcnt(15)
    v_mfma_f32_32x32x16_bf16 v[64:79], v[204:207], v[140:143], v[64:79]
    ds_read_b64_tr_b16 v[192:193], v18 offset:16384
    ds_read_b64_tr_b16 v[194:195], v18 offset:17408
    v_mfma_f32_32x32x16_bf16 v[64:79], v[208:211], v[144:147], v[64:79]
    ds_read_b64_tr_b16 v[196:197], v18 offset:18432
    ds_read_b64_tr_b16 v[198:199], v18 offset:19456
    s_waitcnt lgkmcnt(8)
    v_mfma_f32_32x32x16_bf16 v[64:79], v[212:215], v[148:151], v[64:79]
    ds_read_b64_tr_b16 v[200:201], v18 offset:20480
    ds_read_b64_tr_b16 v[202:203], v18 offset:21504
    s_waitcnt lgkmcnt(8)
    v_mfma_f32_32x32x16_bf16 v[64:79], v[216:219], v[152:155], v[64:79]
    ds_read_b64_tr_b16 v[204:205], v18 offset:22528
    ds_read_b64_tr_b16 v[206:207], v18 offset:23552
    s_waitcnt lgkmcnt(8)
    v_mfma_f32_32x32x16_bf16 v[64:79], v[220:223], v[156:159], v[64:79]
    ds_read_b64_tr_b16 v[208:209], v18 offset:40960
    ds_read_b64_tr_b16 v[210:211], v18 offset:41984
    s_waitcnt lgkmcnt(8)
    v_mfma_f32_32x32x16_bf16 v[64:79], v[192:195], v[160:163], v[64:79]
    ds_read_b64_tr_b16 v[212:213], v18 offset:43008
    ds_read_b64_tr_b16 v[214:215], v18 offset:44032
    s_waitcnt lgkmcnt(8)
    v_mfma_f32_32x32x16_bf16 v[64:79], v[196:199], v[164:167], v[64:79]
    ds_read_b64_tr_b16 v[216:217], v18 offset:45056
    ds_read_b64_tr_b16 v[218:219], v18 offset:46080
    s_waitcnt lgkmcnt(8)
    v_mfma_f32_32x32x16_bf16 v[64:79], v[200:203], v[168:171], v[64:79]
    ds_read_b64_tr_b16 v[220:221], v18 offset:47104
    ds_read_b64_tr_b16 v[222:223], v18 offset:48128
    s_waitcnt lgkmcnt(8)
    v_mfma_f32_32x32x16_bf16 v[64:79], v[204:207], v[172:175], v[64:79]
    s_barrier
    ds_read_b64_tr_b16 v[192:193], v17 offset:0
    ds_read_b64_tr_b16 v[194:195], v17 offset:1024
    s_waitcnt lgkmcnt(8)
    v_mfma_f32_32x32x16_bf16 v[64:79], v[208:211], v[176:179], v[64:79]
    ds_read_b64_tr_b16 v[196:197], v17 offset:2048
    ds_read_b64_tr_b16 v[198:199], v17 offset:3072
    s_waitcnt lgkmcnt(8)
    v_mfma_f32_32x32x16_bf16 v[64:79], v[212:215], v[180:183], v[64:79]
    ds_read_b64_tr_b16 v[200:201], v17 offset:4096
    ds_read_b64_tr_b16 v[202:203], v17 offset:5120
    s_waitcnt lgkmcnt(8)
    v_mfma_f32_32x32x16_bf16 v[64:79], v[216:219], v[184:187], v[64:79]
    ds_read_b64_tr_b16 v[204:205], v17 offset:6144
    ds_read_b64_tr_b16 v[206:207], v17 offset:7168
    s_waitcnt lgkmcnt(8)
    v_mfma_f32_32x32x16_bf16 v[64:79], v[220:223], v[188:191], v[64:79]
    ds_read_b64_tr_b16 v[208:209], v17 offset:24576
    ds_read_b64_tr_b16 v[210:211], v17 offset:25600
    s_waitcnt lgkmcnt(8)
    v_mfma_f32_32x32x16_bf16 v[80:95], v[192:195], v[128:131], 0
    ds_read_b64_tr_b16 v[212:213], v17 offset:26624
    ds_read_b64_tr_b16 v[214:215], v17 offset:27648
    s_waitcnt lgkmcnt(8)
    v_mfma_f32_32x32x16_bf16 v[80:95], v[196:199], v[132:135], v[80:95]
    ds_read_b64_tr_b16 v[216:217], v17 offset:28672
    ds_read_b64_tr_b16 v[218:219], v17 offset:29696
    s_waitcnt lgkmcnt(8)
    v_mfma_f32_32x32x16_bf16 v[80:95], v[200:203], v[136:139], v[80:95]
    ds_read_b64_tr_b16 v[220:221], v17 offset:30720
    ds_read_b64_tr_b16 v[222:223], v17 offset:31744
    s_waitcnt lgkmcnt(8)
    v_mfma_f32_32x32x16_bf16 v[80:95], v[204:207], v[140:143], v[80:95]
    ds_read_b64_tr_b16 v[192:193], v18 offset:0
    ds_read_b64_tr_b16 v[194:195], v18 offset:1024
    v_mul_f32 v64, v44, v64
    v_mul_f32 v65, v44, v65
    v_cvt_pk_bf16_f32 v28, v64, v65
    s_waitcnt lgkmcnt(8)
    v_mfma_f32_32x32x16_bf16 v[80:95], v[208:211], v[144:147], v[80:95]
    v_mul_f32 v66, v44, v66
    v_mul_f32 v67, v44, v67
    ds_read_b64_tr_b16 v[196:197], v18 offset:2048
    ds_read_b64_tr_b16 v[198:199], v18 offset:3072
    s_waitcnt lgkmcnt(8)
    v_mfma_f32_32x32x16_bf16 v[80:95], v[212:215], v[148:151], v[80:95]
    v_cvt_pk_bf16_f32 v29, v66, v67
    v_mul_f32 v68, v44, v68
    ds_read_b64_tr_b16 v[200:201], v18 offset:4096
    ds_read_b64_tr_b16 v[202:203], v18 offset:5120
    s_waitcnt lgkmcnt(8)
    v_mfma_f32_32x32x16_bf16 v[80:95], v[216:219], v[152:155], v[80:95]
    v_mul_f32 v69, v44, v69
    v_cvt_pk_bf16_f32 v30, v68, v69
    ds_read_b64_tr_b16 v[204:205], v18 offset:6144
    ds_read_b64_tr_b16 v[206:207], v18 offset:7168
    s_waitcnt lgkmcnt(8)
    v_mfma_f32_32x32x16_bf16 v[80:95], v[220:223], v[156:159], v[80:95]
    v_mul_f32 v70, v44, v70
    v_mul_f32 v71, v44, v71
    ds_read_b64_tr_b16 v[208:209], v18 offset:24576
    ds_read_b64_tr_b16 v[210:211], v18 offset:25600
    s_waitcnt lgkmcnt(8)
    v_mfma_f32_32x32x16_bf16 v[80:95], v[192:195], v[160:163], v[80:95]
    v_cvt_pk_bf16_f32 v31, v70, v71
    buffer_store_dwordx4 v[28:31], v21, s[40:43], s91 offen sc1
    ds_read_b64_tr_b16 v[212:213], v18 offset:26624
    ds_read_b64_tr_b16 v[214:215], v18 offset:27648
    s_waitcnt lgkmcnt(8)
    v_mfma_f32_32x32x16_bf16 v[80:95], v[196:199], v[164:167], v[80:95]
    v_mul_f32 v72, v44, v72
    v_mul_f32 v73, v44, v73
    v_cvt_pk_bf16_f32 v32, v72, v73
    ds_read_b64_tr_b16 v[216:217], v18 offset:28672
    ds_read_b64_tr_b16 v[218:219], v18 offset:29696
    s_waitcnt lgkmcnt(8)
    v_mfma_f32_32x32x16_bf16 v[80:95], v[200:203], v[168:171], v[80:95]
    v_mul_f32 v74, v44, v74
    v_mul_f32 v75, v44, v75
    ds_read_b64_tr_b16 v[220:221], v18 offset:30720
    ds_read_b64_tr_b16 v[222:223], v18 offset:31744
    s_waitcnt lgkmcnt(8)
    v_mfma_f32_32x32x16_bf16 v[80:95], v[204:207], v[172:175], v[80:95]
    v_cvt_pk_bf16_f32 v33, v74, v75
    v_mul_f32 v76, v44, v76
    s_barrier
    ds_read_b64_tr_b16 v[192:193], v17 offset:8192
    ds_read_b64_tr_b16 v[194:195], v17 offset:9216
    s_waitcnt lgkmcnt(8)
    v_mfma_f32_32x32x16_bf16 v[80:95], v[208:211], v[176:179], v[80:95]
    v_mul_f32 v77, v44, v77
    v_cvt_pk_bf16_f32 v34, v76, v77
    ds_read_b64_tr_b16 v[196:197], v17 offset:10240
    ds_read_b64_tr_b16 v[198:199], v17 offset:11264
    s_waitcnt lgkmcnt(8)
    v_mfma_f32_32x32x16_bf16 v[80:95], v[212:215], v[180:183], v[80:95]
    v_mul_f32 v78, v44, v78
    v_mul_f32 v79, v44, v79
    ds_read_b64_tr_b16 v[200:201], v17 offset:12288
    ds_read_b64_tr_b16 v[202:203], v17 offset:13312
    s_waitcnt lgkmcnt(8)
    v_mfma_f32_32x32x16_bf16 v[80:95], v[216:219], v[184:187], v[80:95]
    v_cvt_pk_bf16_f32 v35, v78, v79
    buffer_store_dwordx4 v[32:35], v21, s[40:43], s91 offen offset:1024 sc1
    ds_read_b64_tr_b16 v[204:205], v17 offset:14336
    ds_read_b64_tr_b16 v[206:207], v17 offset:15360
    s_waitcnt lgkmcnt(8)
    v_mfma_f32_32x32x16_bf16 v[80:95], v[220:223], v[188:191], v[80:95]
    ds_read_b64_tr_b16 v[208:209], v17 offset:32768
    ds_read_b64_tr_b16 v[210:211], v17 offset:33792
    s_waitcnt lgkmcnt(8)
    v_mfma_f32_32x32x16_bf16 v[64:79], v[192:195], v[128:131], 0
    ds_read_b64_tr_b16 v[212:213], v17 offset:34816
    ds_read_b64_tr_b16 v[214:215], v17 offset:35840
    s_waitcnt lgkmcnt(8)
    v_mfma_f32_32x32x16_bf16 v[64:79], v[196:199], v[132:135], v[64:79]
    ds_read_b64_tr_b16 v[216:217], v17 offset:36864
    ds_read_b64_tr_b16 v[218:219], v17 offset:37888
    s_waitcnt lgkmcnt(8)
    v_mfma_f32_32x32x16_bf16 v[64:79], v[200:203], v[136:139], v[64:79]
    ds_read_b64_tr_b16 v[220:221], v17 offset:38912
    ds_read_b64_tr_b16 v[222:223], v17 offset:39936
    s_waitcnt lgkmcnt(8)
    v_mfma_f32_32x32x16_bf16 v[64:79], v[204:207], v[140:143], v[64:79]
    ds_read_b64_tr_b16 v[192:193], v18 offset:8192
    ds_read_b64_tr_b16 v[194:195], v18 offset:9216
    v_mul_f32 v80, v44, v80
    v_mul_f32 v81, v44, v81
    v_cvt_pk_bf16_f32 v36, v80, v81
    s_waitcnt lgkmcnt(8)
    v_mfma_f32_32x32x16_bf16 v[64:79], v[208:211], v[144:147], v[64:79]
    v_mul_f32 v82, v44, v82
    v_mul_f32 v83, v44, v83
    ds_read_b64_tr_b16 v[196:197], v18 offset:10240
    ds_read_b64_tr_b16 v[198:199], v18 offset:11264
    s_waitcnt lgkmcnt(8)
    v_mfma_f32_32x32x16_bf16 v[64:79], v[212:215], v[148:151], v[64:79]
    v_cvt_pk_bf16_f32 v37, v82, v83
    v_mul_f32 v84, v44, v84
    ds_read_b64_tr_b16 v[200:201], v18 offset:12288
    ds_read_b64_tr_b16 v[202:203], v18 offset:13312
    s_waitcnt lgkmcnt(8)
    v_mfma_f32_32x32x16_bf16 v[64:79], v[216:219], v[152:155], v[64:79]
    v_mul_f32 v85, v44, v85
    v_cvt_pk_bf16_f32 v38, v84, v85
    ds_read_b64_tr_b16 v[204:205], v18 offset:14336
    ds_read_b64_tr_b16 v[206:207], v18 offset:15360
    s_waitcnt lgkmcnt(8)
    v_mfma_f32_32x32x16_bf16 v[64:79], v[220:223], v[156:159], v[64:79]
    v_mul_f32 v86, v44, v86
    v_mul_f32 v87, v44, v87
    ds_read_b64_tr_b16 v[208:209], v18 offset:32768
    ds_read_b64_tr_b16 v[210:211], v18 offset:33792
    s_waitcnt lgkmcnt(8)
    v_mfma_f32_32x32x16_bf16 v[64:79], v[192:195], v[160:163], v[64:79]
    v_cvt_pk_bf16_f32 v39, v86, v87
    buffer_store_dwordx4 v[36:39], v21, s[40:43], s92 offen sc1
    ds_read_b64_tr_b16 v[212:213], v18 offset:34816
    ds_read_b64_tr_b16 v[214:215], v18 offset:35840
    s_waitcnt lgkmcnt(8)
    v_mfma_f32_32x32x16_bf16 v[64:79], v[196:199], v[164:167], v[64:79]
    v_mul_f32 v88, v44, v88
    v_mul_f32 v89, v44, v89
    v_cvt_pk_bf16_f32 v40, v88, v89
    ds_read_b64_tr_b16 v[216:217], v18 offset:36864
    ds_read_b64_tr_b16 v[218:219], v18 offset:37888
    s_waitcnt lgkmcnt(8)
    v_mfma_f32_32x32x16_bf16 v[64:79], v[200:203], v[168:171], v[64:79]
    v_mul_f32 v90, v44, v90
    v_mul_f32 v91, v44, v91
    ds_read_b64_tr_b16 v[220:221], v18 offset:38912
    ds_read_b64_tr_b16 v[222:223], v18 offset:39936
    s_waitcnt lgkmcnt(8)
    v_mfma_f32_32x32x16_bf16 v[64:79], v[204:207], v[172:175], v[64:79]
    v_cvt_pk_bf16_f32 v41, v90, v91
    v_mul_f32 v92, v44, v92
    s_barrier
    ds_read_b64_tr_b16 v[192:193], v19 offset:0
    ds_read_b64_tr_b16 v[194:195], v19 offset:1024
    s_waitcnt lgkmcnt(8)
    v_mfma_f32_32x32x16_bf16 v[64:79], v[208:211], v[176:179], v[64:79]
    v_mul_f32 v93, v44, v93
    v_cvt_pk_bf16_f32 v42, v92, v93
    ds_read_b64_tr_b16 v[196:197], v19 offset:2048
    ds_read_b64_tr_b16 v[198:199], v19 offset:3072
    s_waitcnt lgkmcnt(8)
    v_mfma_f32_32x32x16_bf16 v[64:79], v[212:215], v[180:183], v[64:79]
    v_mul_f32 v94, v44, v94
    v_mul_f32 v95, v44, v95
    ds_read_b64_tr_b16 v[200:201], v19 offset:4096
    ds_read_b64_tr_b16 v[202:203], v19 offset:5120
    s_waitcnt lgkmcnt(8)
    v_mfma_f32_32x32x16_bf16 v[64:79], v[216:219], v[184:187], v[64:79]
    v_cvt_pk_bf16_f32 v43, v94, v95
    buffer_store_dwordx4 v[40:43], v21, s[40:43], s92 offen offset:1024 sc1
    ds_read_b64_tr_b16 v[204:205], v19 offset:6144
    ds_read_b64_tr_b16 v[206:207], v19 offset:7168
    s_waitcnt lgkmcnt(8)
    v_mfma_f32_32x32x16_bf16 v[64:79], v[220:223], v[188:191], v[64:79]
    ds_read_b64_tr_b16 v[208:209], v19 offset:8192
    ds_read_b64_tr_b16 v[210:211], v19 offset:9216
    s_waitcnt lgkmcnt(8)
    v_mfma_f32_32x32x16_bf16 v[80:95], v[192:195], v[128:131], 0
    ds_read_b64_tr_b16 v[212:213], v19 offset:10240
    ds_read_b64_tr_b16 v[214:215], v19 offset:11264
    s_waitcnt lgkmcnt(8)
    v_mfma_f32_32x32x16_bf16 v[80:95], v[196:199], v[132:135], v[80:95]
    ds_read_b64_tr_b16 v[216:217], v19 offset:12288
    ds_read_b64_tr_b16 v[218:219], v19 offset:13312
    s_waitcnt lgkmcnt(8)
    v_mfma_f32_32x32x16_bf16 v[80:95], v[200:203], v[136:139], v[80:95]
    ds_read_b64_tr_b16 v[220:221], v19 offset:14336
    ds_read_b64_tr_b16 v[222:223], v19 offset:15360
    s_waitcnt lgkmcnt(8)
    v_mfma_f32_32x32x16_bf16 v[80:95], v[204:207], v[140:143], v[80:95]
    ds_read_b64_tr_b16 v[192:193], v19 offset:16384
    ds_read_b64_tr_b16 v[194:195], v19 offset:17408
    v_mul_f32 v64, v44, v64
    v_mul_f32 v65, v44, v65
    v_cvt_pk_bf16_f32 v28, v64, v65
    s_waitcnt lgkmcnt(8)
    v_mfma_f32_32x32x16_bf16 v[80:95], v[208:211], v[144:147], v[80:95]
    v_mul_f32 v66, v44, v66
    v_mul_f32 v67, v44, v67
    ds_read_b64_tr_b16 v[196:197], v19 offset:18432
    ds_read_b64_tr_b16 v[198:199], v19 offset:19456
    s_waitcnt lgkmcnt(8)
    v_mfma_f32_32x32x16_bf16 v[80:95], v[212:215], v[148:151], v[80:95]
    v_cvt_pk_bf16_f32 v29, v66, v67
    v_mul_f32 v68, v44, v68
    ds_read_b64_tr_b16 v[200:201], v19 offset:20480
    ds_read_b64_tr_b16 v[202:203], v19 offset:21504
    s_waitcnt lgkmcnt(8)
    v_mfma_f32_32x32x16_bf16 v[80:95], v[216:219], v[152:155], v[80:95]
    v_mul_f32 v69, v44, v69
    v_cvt_pk_bf16_f32 v30, v68, v69
    ds_read_b64_tr_b16 v[204:205], v19 offset:22528
    ds_read_b64_tr_b16 v[206:207], v19 offset:23552
    s_waitcnt lgkmcnt(8)
    v_mfma_f32_32x32x16_bf16 v[80:95], v[220:223], v[156:159], v[80:95]
    v_mul_f32 v70, v44, v70
    v_mul_f32 v71, v44, v71
    ds_read_b64_tr_b16 v[208:209], v19 offset:24576
    ds_read_b64_tr_b16 v[210:211], v19 offset:25600
    s_waitcnt lgkmcnt(8)
    v_mfma_f32_32x32x16_bf16 v[80:95], v[192:195], v[160:163], v[80:95]
    v_cvt_pk_bf16_f32 v31, v70, v71
    buffer_store_dwordx4 v[28:31], v21, s[40:43], s93 offen sc1
    ds_read_b64_tr_b16 v[212:213], v19 offset:26624
    ds_read_b64_tr_b16 v[214:215], v19 offset:27648
    s_waitcnt lgkmcnt(8)
    v_mfma_f32_32x32x16_bf16 v[80:95], v[196:199], v[164:167], v[80:95]
    v_mul_f32 v72, v44, v72
    v_mul_f32 v73, v44, v73
    v_cvt_pk_bf16_f32 v32, v72, v73
    ds_read_b64_tr_b16 v[216:217], v19 offset:28672
    ds_read_b64_tr_b16 v[218:219], v19 offset:29696
    s_waitcnt lgkmcnt(8)
    v_mfma_f32_32x32x16_bf16 v[80:95], v[200:203], v[168:171], v[80:95]
    v_mul_f32 v74, v44, v74
    v_mul_f32 v75, v44, v75
    ds_read_b64_tr_b16 v[220:221], v19 offset:30720
    ds_read_b64_tr_b16 v[222:223], v19 offset:31744
    s_waitcnt lgkmcnt(8)
    v_mfma_f32_32x32x16_bf16 v[80:95], v[204:207], v[172:175], v[80:95]
    v_cvt_pk_bf16_f32 v33, v74, v75
    v_mul_f32 v76, v44, v76
    s_barrier
    ds_read_b64_tr_b16 v[192:193], v19 offset:32768
    ds_read_b64_tr_b16 v[194:195], v19 offset:33792
    s_waitcnt lgkmcnt(8)
    v_mfma_f32_32x32x16_bf16 v[80:95], v[208:211], v[176:179], v[80:95]
    v_mul_f32 v77, v44, v77
    v_cvt_pk_bf16_f32 v34, v76, v77
    ds_read_b64_tr_b16 v[196:197], v19 offset:34816
    ds_read_b64_tr_b16 v[198:199], v19 offset:35840
    s_waitcnt lgkmcnt(8)
    v_mfma_f32_32x32x16_bf16 v[80:95], v[212:215], v[180:183], v[80:95]
    v_mul_f32 v78, v44, v78
    v_mul_f32 v79, v44, v79
    ds_read_b64_tr_b16 v[200:201], v19 offset:36864
    ds_read_b64_tr_b16 v[202:203], v19 offset:37888
    s_waitcnt lgkmcnt(8)
    v_mfma_f32_32x32x16_bf16 v[80:95], v[216:219], v[184:187], v[80:95]
    v_cvt_pk_bf16_f32 v35, v78, v79
    buffer_store_dwordx4 v[32:35], v21, s[40:43], s93 offen offset:1024 sc1
    ds_read_b64_tr_b16 v[204:205], v19 offset:38912
    ds_read_b64_tr_b16 v[206:207], v19 offset:39936
    s_waitcnt lgkmcnt(8)
    v_mfma_f32_32x32x16_bf16 v[80:95], v[220:223], v[188:191], v[80:95]
    ds_read_b64_tr_b16 v[208:209], v19 offset:40960
    ds_read_b64_tr_b16 v[210:211], v19 offset:41984
    s_waitcnt lgkmcnt(8)
    v_mfma_f32_32x32x16_bf16 v[64:79], v[192:195], v[128:131], 0
    ds_read_b64_tr_b16 v[212:213], v19 offset:43008
    ds_read_b64_tr_b16 v[214:215], v19 offset:44032
    s_waitcnt lgkmcnt(8)
    v_mfma_f32_32x32x16_bf16 v[64:79], v[196:199], v[132:135], v[64:79]
    ds_read_b64_tr_b16 v[216:217], v19 offset:45056
    ds_read_b64_tr_b16 v[218:219], v19 offset:46080
    s_waitcnt lgkmcnt(8)
    v_mfma_f32_32x32x16_bf16 v[64:79], v[200:203], v[136:139], v[64:79]
    ds_read_b64_tr_b16 v[220:221], v19 offset:47104
    ds_read_b64_tr_b16 v[222:223], v19 offset:48128
    s_waitcnt lgkmcnt(8)
    v_mfma_f32_32x32x16_bf16 v[64:79], v[204:207], v[140:143], v[64:79]
    ds_read_b64_tr_b16 v[192:193], v19 offset:49152
    ds_read_b64_tr_b16 v[194:195], v19 offset:50176
    v_mul_f32 v80, v44, v80
    v_mul_f32 v81, v44, v81
    v_cvt_pk_bf16_f32 v36, v80, v81
    s_waitcnt lgkmcnt(8)
    v_mfma_f32_32x32x16_bf16 v[64:79], v[208:211], v[144:147], v[64:79]
    v_mul_f32 v82, v44, v82
    v_mul_f32 v83, v44, v83
    ds_read_b64_tr_b16 v[196:197], v19 offset:51200
    ds_read_b64_tr_b16 v[198:199], v19 offset:52224
    s_waitcnt lgkmcnt(8)
    v_mfma_f32_32x32x16_bf16 v[64:79], v[212:215], v[148:151], v[64:79]
    v_cvt_pk_bf16_f32 v37, v82, v83
    v_mul_f32 v84, v44, v84
    ds_read_b64_tr_b16 v[200:201], v19 offset:53248
    ds_read_b64_tr_b16 v[202:203], v19 offset:54272
    s_waitcnt lgkmcnt(8)
    v_mfma_f32_32x32x16_bf16 v[64:79], v[216:219], v[152:155], v[64:79]
    v_mul_f32 v85, v44, v85
    v_cvt_pk_bf16_f32 v38, v84, v85
    ds_read_b64_tr_b16 v[204:205], v19 offset:55296
    ds_read_b64_tr_b16 v[206:207], v19 offset:56320
    s_waitcnt lgkmcnt(8)
    v_mfma_f32_32x32x16_bf16 v[64:79], v[220:223], v[156:159], v[64:79]
    v_mul_f32 v86, v44, v86
    v_mul_f32 v87, v44, v87
    ds_read_b64_tr_b16 v[208:209], v19 offset:57344
    ds_read_b64_tr_b16 v[210:211], v19 offset:58368
    s_waitcnt lgkmcnt(8)
    v_mfma_f32_32x32x16_bf16 v[64:79], v[192:195], v[160:163], v[64:79]
    v_cvt_pk_bf16_f32 v39, v86, v87
    buffer_store_dwordx4 v[36:39], v21, s[40:43], s94 offen sc1
    ds_read_b64_tr_b16 v[212:213], v19 offset:59392
    ds_read_b64_tr_b16 v[214:215], v19 offset:60416
    s_waitcnt lgkmcnt(8)
    v_mfma_f32_32x32x16_bf16 v[64:79], v[196:199], v[164:167], v[64:79]
    v_mul_f32 v88, v44, v88
    v_mul_f32 v89, v44, v89
    v_cvt_pk_bf16_f32 v40, v88, v89
    ds_read_b64_tr_b16 v[216:217], v19 offset:61440
    ds_read_b64_tr_b16 v[218:219], v19 offset:62464
    s_waitcnt lgkmcnt(8)
    v_mfma_f32_32x32x16_bf16 v[64:79], v[200:203], v[168:171], v[64:79]
    v_mul_f32 v90, v44, v90
    v_mul_f32 v91, v44, v91
    ds_read_b64_tr_b16 v[220:221], v19 offset:63488
    ds_read_b64_tr_b16 v[222:223], v19 offset:64512
    s_waitcnt lgkmcnt(8)
    v_mfma_f32_32x32x16_bf16 v[64:79], v[204:207], v[172:175], v[64:79]
    v_cvt_pk_bf16_f32 v41, v90, v91
    v_mul_f32 v92, v44, v92
    s_barrier
    ds_read_b64_tr_b16 v[192:193], v17 offset:16384
    ds_read_b64_tr_b16 v[194:195], v17 offset:17408
    s_waitcnt lgkmcnt(8)
    v_mfma_f32_32x32x16_bf16 v[64:79], v[208:211], v[176:179], v[64:79]
    v_mul_f32 v93, v44, v93
    v_cvt_pk_bf16_f32 v42, v92, v93
    ds_read_b64_tr_b16 v[196:197], v17 offset:18432
    ds_read_b64_tr_b16 v[198:199], v17 offset:19456
    s_waitcnt lgkmcnt(8)
    v_mfma_f32_32x32x16_bf16 v[64:79], v[212:215], v[180:183], v[64:79]
    v_mul_f32 v94, v44, v94
    v_mul_f32 v95, v44, v95
    ds_read_b64_tr_b16 v[200:201], v17 offset:20480
    ds_read_b64_tr_b16 v[202:203], v17 offset:21504
    s_waitcnt lgkmcnt(8)
    v_mfma_f32_32x32x16_bf16 v[64:79], v[216:219], v[184:187], v[64:79]
    v_cvt_pk_bf16_f32 v43, v94, v95
    buffer_store_dwordx4 v[40:43], v21, s[40:43], s94 offen offset:1024 sc1
    ds_read_b64_tr_b16 v[204:205], v17 offset:22528
    ds_read_b64_tr_b16 v[206:207], v17 offset:23552
    s_waitcnt lgkmcnt(8)
    v_mfma_f32_32x32x16_bf16 v[64:79], v[220:223], v[188:191], v[64:79]
    ds_read_b64_tr_b16 v[208:209], v17 offset:40960
    ds_read_b64_tr_b16 v[210:211], v17 offset:41984
    s_waitcnt lgkmcnt(8)
    v_mfma_f32_32x32x16_bf16 v[80:95], v[192:195], v[128:131], 0
    ds_read_b64_tr_b16 v[212:213], v17 offset:43008
    ds_read_b64_tr_b16 v[214:215], v17 offset:44032
    s_waitcnt lgkmcnt(8)
    v_mfma_f32_32x32x16_bf16 v[80:95], v[196:199], v[132:135], v[80:95]
    ds_read_b64_tr_b16 v[216:217], v17 offset:45056
    ds_read_b64_tr_b16 v[218:219], v17 offset:46080
    s_waitcnt lgkmcnt(8)
    v_mfma_f32_32x32x16_bf16 v[80:95], v[200:203], v[136:139], v[80:95]
    ds_read_b64_tr_b16 v[220:221], v17 offset:47104
    ds_read_b64_tr_b16 v[222:223], v17 offset:48128
    s_waitcnt lgkmcnt(8)
    v_mfma_f32_32x32x16_bf16 v[80:95], v[204:207], v[140:143], v[80:95]
    ds_read_b64_tr_b16 v[192:193], v18 offset:16384
    ds_read_b64_tr_b16 v[194:195], v18 offset:17408
    v_mul_f32 v64, v44, v64
    v_mul_f32 v65, v44, v65
    v_cvt_pk_bf16_f32 v28, v64, v65
    s_waitcnt lgkmcnt(8)
    v_mfma_f32_32x32x16_bf16 v[80:95], v[208:211], v[144:147], v[80:95]
    v_mul_f32 v66, v44, v66
    v_mul_f32 v67, v44, v67
    ds_read_b64_tr_b16 v[196:197], v18 offset:18432
    ds_read_b64_tr_b16 v[198:199], v18 offset:19456
    s_waitcnt lgkmcnt(8)
    v_mfma_f32_32x32x16_bf16 v[80:95], v[212:215], v[148:151], v[80:95]
    v_cvt_pk_bf16_f32 v29, v66, v67
    v_mul_f32 v68, v44, v68
    ds_read_b64_tr_b16 v[200:201], v18 offset:20480
    ds_read_b64_tr_b16 v[202:203], v18 offset:21504
    s_waitcnt lgkmcnt(8)
    v_mfma_f32_32x32x16_bf16 v[80:95], v[216:219], v[152:155], v[80:95]
    v_mul_f32 v69, v44, v69
    v_cvt_pk_bf16_f32 v30, v68, v69
    ds_read_b64_tr_b16 v[204:205], v18 offset:22528
    ds_read_b64_tr_b16 v[206:207], v18 offset:23552
    s_waitcnt lgkmcnt(8)
    v_mfma_f32_32x32x16_bf16 v[80:95], v[220:223], v[156:159], v[80:95]
    v_mul_f32 v70, v44, v70
    v_mul_f32 v71, v44, v71
    ds_read_b64_tr_b16 v[208:209], v18 offset:40960
    ds_read_b64_tr_b16 v[210:211], v18 offset:41984
    s_waitcnt lgkmcnt(8)
    v_mfma_f32_32x32x16_bf16 v[80:95], v[192:195], v[160:163], v[80:95]
    v_cvt_pk_bf16_f32 v31, v70, v71
    buffer_store_dwordx4 v[28:31], v21, s[40:43], s95 offen sc1
    ds_read_b64_tr_b16 v[212:213], v18 offset:43008
    ds_read_b64_tr_b16 v[214:215], v18 offset:44032
    s_waitcnt lgkmcnt(8)
    v_mfma_f32_32x32x16_bf16 v[80:95], v[196:199], v[164:167], v[80:95]
    v_mul_f32 v72, v44, v72
    v_mul_f32 v73, v44, v73
    v_cvt_pk_bf16_f32 v32, v72, v73
    ds_read_b64_tr_b16 v[216:217], v18 offset:45056
    ds_read_b64_tr_b16 v[218:219], v18 offset:46080
    s_waitcnt lgkmcnt(8)
    v_mfma_f32_32x32x16_bf16 v[80:95], v[200:203], v[168:171], v[80:95]
    v_mul_f32 v74, v44, v74
    v_mul_f32 v75, v44, v75
    ds_read_b64_tr_b16 v[220:221], v18 offset:47104
    ds_read_b64_tr_b16 v[222:223], v18 offset:48128
    s_waitcnt lgkmcnt(8)
    v_mfma_f32_32x32x16_bf16 v[80:95], v[204:207], v[172:175], v[80:95]
    v_cvt_pk_bf16_f32 v33, v74, v75
    v_mul_f32 v76, v44, v76
    s_barrier
    ds_read_b64_tr_b16 v[192:193], v17 offset:0
    ds_read_b64_tr_b16 v[194:195], v17 offset:1024
    s_waitcnt lgkmcnt(8)
    v_mfma_f32_32x32x16_bf16 v[80:95], v[208:211], v[176:179], v[80:95]
    v_mul_f32 v77, v44, v77
    v_cvt_pk_bf16_f32 v34, v76, v77
    ds_read_b64_tr_b16 v[196:197], v17 offset:2048
    ds_read_b64_tr_b16 v[198:199], v17 offset:3072
    s_waitcnt lgkmcnt(8)
    v_mfma_f32_32x32x16_bf16 v[80:95], v[212:215], v[180:183], v[80:95]
    v_mul_f32 v78, v44, v78
    v_mul_f32 v79, v44, v79
    ds_read_b64_tr_b16 v[200:201], v17 offset:4096
    ds_read_b64_tr_b16 v[202:203], v17 offset:5120
    s_waitcnt lgkmcnt(8)
    v_mfma_f32_32x32x16_bf16 v[80:95], v[216:219], v[184:187], v[80:95]
    v_cvt_pk_bf16_f32 v35, v78, v79
    buffer_store_dwordx4 v[32:35], v21, s[40:43], s95 offen offset:1024 sc1
    ds_read_b64_tr_b16 v[204:205], v17 offset:6144
    ds_read_b64_tr_b16 v[206:207], v17 offset:7168
    s_waitcnt lgkmcnt(8)
    v_mfma_f32_32x32x16_bf16 v[80:95], v[220:223], v[188:191], v[80:95]
    ds_read_b64_tr_b16 v[208:209], v17 offset:24576
    ds_read_b64_tr_b16 v[210:211], v17 offset:25600
    s_waitcnt lgkmcnt(8)
    v_mfma_f32_32x32x16_bf16 v[64:79], v[192:195], v[128:131], 0
    ds_read_b64_tr_b16 v[212:213], v17 offset:26624
    ds_read_b64_tr_b16 v[214:215], v17 offset:27648
    s_waitcnt lgkmcnt(8)
    v_mfma_f32_32x32x16_bf16 v[64:79], v[196:199], v[132:135], v[64:79]
    ds_read_b64_tr_b16 v[216:217], v17 offset:28672
    ds_read_b64_tr_b16 v[218:219], v17 offset:29696
    s_waitcnt lgkmcnt(8)
    v_mfma_f32_32x32x16_bf16 v[64:79], v[200:203], v[136:139], v[64:79]
    ds_read_b64_tr_b16 v[220:221], v17 offset:30720
    ds_read_b64_tr_b16 v[222:223], v17 offset:31744
    s_waitcnt lgkmcnt(8)
    v_mfma_f32_32x32x16_bf16 v[64:79], v[204:207], v[140:143], v[64:79]
    ds_read_b64_tr_b16 v[192:193], v18 offset:0
    ds_read_b64_tr_b16 v[194:195], v18 offset:1024
    v_mul_f32 v80, v44, v80
    v_mul_f32 v81, v44, v81
    v_cvt_pk_bf16_f32 v36, v80, v81
    s_waitcnt lgkmcnt(8)
    v_mfma_f32_32x32x16_bf16 v[64:79], v[208:211], v[144:147], v[64:79]
    v_mul_f32 v82, v44, v82
    v_mul_f32 v83, v44, v83
    ds_read_b64_tr_b16 v[196:197], v18 offset:2048
    ds_read_b64_tr_b16 v[198:199], v18 offset:3072
    s_waitcnt lgkmcnt(8)
    v_mfma_f32_32x32x16_bf16 v[64:79], v[212:215], v[148:151], v[64:79]
    v_cvt_pk_bf16_f32 v37, v82, v83
    v_mul_f32 v84, v44, v84
    ds_read_b64_tr_b16 v[200:201], v18 offset:4096
    ds_read_b64_tr_b16 v[202:203], v18 offset:5120
    s_waitcnt lgkmcnt(8)
    v_mfma_f32_32x32x16_bf16 v[64:79], v[216:219], v[152:155], v[64:79]
    v_mul_f32 v85, v44, v85
    v_cvt_pk_bf16_f32 v38, v84, v85
    ds_read_b64_tr_b16 v[204:205], v18 offset:6144
    ds_read_b64_tr_b16 v[206:207], v18 offset:7168
    s_waitcnt lgkmcnt(8)
    v_mfma_f32_32x32x16_bf16 v[64:79], v[220:223], v[156:159], v[64:79]
    v_mul_f32 v86, v44, v86
    v_mul_f32 v87, v44, v87
    ds_read_b64_tr_b16 v[208:209], v18 offset:24576
    ds_read_b64_tr_b16 v[210:211], v18 offset:25600
    s_waitcnt lgkmcnt(8)
    v_mfma_f32_32x32x16_bf16 v[64:79], v[192:195], v[160:163], v[64:79]
    v_cvt_pk_bf16_f32 v39, v86, v87
    buffer_store_dwordx4 v[36:39], v21, s[40:43], s96 offen sc1
    ds_read_b64_tr_b16 v[212:213], v18 offset:26624
    ds_read_b64_tr_b16 v[214:215], v18 offset:27648
    s_waitcnt lgkmcnt(8)
    v_mfma_f32_32x32x16_bf16 v[64:79], v[196:199], v[164:167], v[64:79]
    v_mul_f32 v88, v44, v88
    v_mul_f32 v89, v44, v89
    v_cvt_pk_bf16_f32 v40, v88, v89
    ds_read_b64_tr_b16 v[216:217], v18 offset:28672
    ds_read_b64_tr_b16 v[218:219], v18 offset:29696
    s_waitcnt lgkmcnt(8)
    v_mfma_f32_32x32x16_bf16 v[64:79], v[200:203], v[168:171], v[64:79]
    v_mul_f32 v90, v44, v90
    v_mul_f32 v91, v44, v91
    ds_read_b64_tr_b16 v[220:221], v18 offset:30720
    ds_read_b64_tr_b16 v[222:223], v18 offset:31744
    s_waitcnt lgkmcnt(8)
    v_mfma_f32_32x32x16_bf16 v[64:79], v[204:207], v[172:175], v[64:79]
    v_cvt_pk_bf16_f32 v41, v90, v91
    v_mul_f32 v92, v44, v92
    s_waitcnt lgkmcnt(6)
    v_mfma_f32_32x32x16_bf16 v[64:79], v[208:211], v[176:179], v[64:79]
    v_mul_f32 v93, v44, v93
    v_cvt_pk_bf16_f32 v42, v92, v93
    s_waitcnt lgkmcnt(4)
    v_mfma_f32_32x32x16_bf16 v[64:79], v[212:215], v[180:183], v[64:79]
    v_mul_f32 v94, v44, v94
    v_mul_f32 v95, v44, v95
    s_waitcnt lgkmcnt(2)
    v_mfma_f32_32x32x16_bf16 v[64:79], v[216:219], v[184:187], v[64:79]
    v_cvt_pk_bf16_f32 v43, v94, v95
    buffer_store_dwordx4 v[40:43], v21, s[40:43], s96 offen offset:1024 sc1
    s_waitcnt lgkmcnt(0)
    v_mfma_f32_32x32x16_bf16 v[64:79], v[220:223], v[188:191], v[64:79]
    s_nop 11
    v_mul_f32 v64, v44, v64
    v_mul_f32 v65, v44, v65
    v_cvt_pk_bf16_f32 v28, v64, v65
    v_mul_f32 v66, v44, v66
    v_mul_f32 v67, v44, v67
    v_cvt_pk_bf16_f32 v29, v66, v67
    v_mul_f32 v68, v44, v68
    v_mul_f32 v69, v44, v69
    v_cvt_pk_bf16_f32 v30, v68, v69
    v_mul_f32 v70, v44, v70
    v_mul_f32 v71, v44, v71
    v_cvt_pk_bf16_f32 v31, v70, v71
    buffer_store_dwordx4 v[28:31], v21, s[40:43], s97 offen sc1
    v_mul_f32 v72, v44, v72
    v_mul_f32 v73, v44, v73
    v_cvt_pk_bf16_f32 v32, v72, v73
    v_mul_f32 v74, v44, v74
    v_mul_f32 v75, v44, v75
    v_cvt_pk_bf16_f32 v33, v74, v75
    v_mul_f32 v76, v44, v76
    v_mul_f32 v77, v44, v77
    v_cvt_pk_bf16_f32 v34, v76, v77
    v_mul_f32 v78, v44, v78
    v_mul_f32 v79, v44, v79
    v_cvt_pk_bf16_f32 v35, v78, v79
    buffer_store_dwordx4 v[32:35], v21, s[40:43], s97 offen offset:1024 sc1
    s_endpgm
L_loader:
    s_mul_i32 s60, s59, 57344
    s_mul_i32 s47, s59, 7
    s_lshr_b32 s47, s47, 4
    s_mul_i32 s48, s56, 3
    s_add_u32 s47, s47, s48
    s_cmp_ge_u32 s47, 7
    s_cselect_b32 s48, 7, 0
    s_sub_u32 s47, s47, s48
    s_add_u32 s48, s47, 0
    s_cmp_ge_u32 s48, 7
    s_cselect_b32 s46, 7, 0
    s_sub_u32 s48, s48, s46
    s_lshl_b32 s84, s48, 7
    v_lshrrev_b32 v21, 4, v0
    v_and_b32 v22, 7, v0
    v_xor_b32 v21, v21, v22
    v_lshlrev_b32 v21, 4, v21
    v_lshrrev_b32 v22, 3, v0
    s_mul_i32 s48, s44, 14336
    v_mul_u32_u24 v20, 896, v22
    v_add_u32 v20, s48, v20
    v_add_u32 v2, v20, v21
    v_xor_b32 v3, 64, v21
    v_add_u32 v20, 6144, v20
    v_add_u32 v3, v3, v20
    s_lshl_b32 s50, s44, 11
    s_lshl_b32 s61, s58, 9
    v_bfe_u32 v20, v0, 4, 1
    v_lshlrev_b32 v20, 2, v20
    v_and_b32 v23, 7, v0
    v_xor_b32 v20, v20, v23
    v_lshlrev_b32 v23, 4, v20
    s_lshl_b32 s48, s44, 7
    v_add_u32 v24, s48, v23
    v_lshl_add_u32 v4, v22, 13, v24
    v_add_u32 v5, 64512, v4
    v_add_u32 v6, 129024, v4
    v_add_u32 v7, 193536, v4
    s_waitcnt lgkmcnt(0)
    s_add_u32 s20, s4, s60
    s_addc_u32 s21, s5, 0
    s_and_b32 s21, s21, 0xffff
    s_mov_b32 s22, 57344
    s_mov_b32 s23, 0x20000
    s_add_u32 m0, s50, 0
    s_mov_b32 s46, s84
    buffer_load_dwordx4 v2, s[20:23], s46 offen lds
    buffer_load_dwordx4 v3, s[20:23], s46 offen offset:1024 lds
    s_add_u32 s24, s10, s61
    s_addc_u32 s25, s11, 0
    s_and_b32 s25, s25, 0xffff
    s_mov_b32 s26, 3662336
    s_mov_b32 s27, 0x20000
    s_add_u32 m0, s45, 0
    s_lshl_b32 s46, s84, 12
    buffer_load_dwordx4 v4, s[24:27], s46 offen lds
    buffer_load_dwordx4 v5, s[24:27], s46 offen offset:1024 lds
    buffer_load_dwordx4 v6, s[24:27], s46 offen offset:2048 lds
    buffer_load_dwordx4 v7, s[24:27], s46 offen offset:3072 lds
    s_add_u32 m0, s45, 4096
    s_lshl_b32 s46, s84, 12
    s_add_u32 s46, s46, 262144
    buffer_load_dwordx4 v4, s[24:27], s46 offen lds
    buffer_load_dwordx4 v5, s[24:27], s46 offen offset:1024 lds
    buffer_load_dwordx4 v6, s[24:27], s46 offen offset:2048 lds
    buffer_load_dwordx4 v7, s[24:27], s46 offen offset:3072 lds
    s_add_u32 s48, s47, 1
    s_cmp_ge_u32 s48, 7
    s_cselect_b32 s46, 7, 0
    s_sub_u32 s48, s48, s46
    s_lshl_b32 s85, s48, 7
    s_add_u32 s48, s47, 2
    s_cmp_ge_u32 s48, 7
    s_cselect_b32 s46, 7, 0
    s_sub_u32 s48, s48, s46
    s_lshl_b32 s86, s48, 7
    s_add_u32 s48, s47, 3
    s_cmp_ge_u32 s48, 7
    s_cselect_b32 s46, 7, 0
    s_sub_u32 s48, s48, s46
    s_lshl_b32 s87, s48, 7
    s_add_u32 s48, s47, 4
    s_cmp_ge_u32 s48, 7
    s_cselect_b32 s46, 7, 0
    s_sub_u32 s48, s48, s46
    s_lshl_b32 s88, s48, 7
    s_add_u32 s48, s47, 5
    s_cmp_ge_u32 s48, 7
    s_cselect_b32 s46, 7, 0
    s_sub_u32 s48, s48, s46
    s_lshl_b32 s89, s48, 7
    s_add_u32 s48, s47, 6
    s_cmp_ge_u32 s48, 7
    s_cselect_b32 s46, 7, 0
    s_sub_u32 s48, s48, s46
    s_lshl_b32 s90, s48, 7
    s_lshl_b32 s62, s55, 3
    s_add_u32 s62, s62, s53
    s_lshl_b32 s62, s62, 18
    s_mul_i32 s63, s58, 229376
    s_add_u32 s28, s6, s62
    s_addc_u32 s29, s7, 0
    s_and_b32 s29, s29, 0xffff
    s_mov_b32 s30, 262144
    s_mov_b32 s31, 0x20000
    s_add_u32 s32, s8, s62
    s_addc_u32 s33, s9, 0
    s_and_b32 s33, s33, 0xffff
    s_mov_b32 s34, 262144
    s_mov_b32 s35, 0x20000
    s_add_u32 s36, s12, s63
    s_addc_u32 s37, s13, 0
    s_and_b32 s37, s37, 0xffff
    s_mov_b32 s38, 229376
    s_mov_b32 s39, 0x20000
    s_lshl_b32 s52, s44, 13
    s_and_b32 s47, s54, 2
    s_add_u32 s48, s47, 0
    s_and_b32 s48, s48, 3
    s_lshl_b32 s80, s48, 16
    s_add_u32 s48, s47, 1
    s_and_b32 s48, s48, 3
    s_lshl_b32 s81, s48, 16
    s_add_u32 s48, s47, 2
    s_and_b32 s48, s48, 3
    s_lshl_b32 s82, s48, 16
    s_add_u32 s48, s47, 3
    s_and_b32 s48, s48, 3
    s_lshl_b32 s83, s48, 16
    s_mul_i32 s47, s59, 7
    s_lshr_b32 s47, s47, 4
    s_add_u32 s48, s47, 0
    s_cmp_ge_u32 s48, 7
    s_cselect_b32 s46, 7, 0
    s_sub_u32 s48, s48, s46
    s_lshl_b32 s91, s48, 7
    s_add_u32 s48, s47, 1
    s_cmp_ge_u32 s48, 7
    s_cselect_b32 s46, 7, 0
    s_sub_u32 s48, s48, s46
    s_lshl_b32 s92, s48, 7
    s_add_u32 s48, s47, 2
    s_cmp_ge_u32 s48, 7
    s_cselect_b32 s46, 7, 0
    s_sub_u32 s48, s48, s46
    s_lshl_b32 s93, s48, 7
    s_add_u32 s48, s47, 3
    s_cmp_ge_u32 s48, 7
    s_cselect_b32 s46, 7, 0
    s_sub_u32 s48, s48, s46
    s_lshl_b32 s94, s48, 7
    s_add_u32 s48, s47, 4
    s_cmp_ge_u32 s48, 7
    s_cselect_b32 s46, 7, 0
    s_sub_u32 s48, s48, s46
    s_lshl_b32 s95, s48, 7
    s_add_u32 s48, s47, 5
    s_cmp_ge_u32 s48, 7
    s_cselect_b32 s46, 7, 0
    s_sub_u32 s48, s48, s46
    s_lshl_b32 s96, s48, 7
    s_add_u32 s48, s47, 6
    s_cmp_ge_u32 s48, 7
    s_cselect_b32 s46, 7, 0
    s_sub_u32 s48, s48, s46
    s_lshl_b32 s97, s48, 7
    s_lshl_b32 s48, s44, 14
    v_lshlrev_b32 v20, 9, v22
    v_add_u32 v20, s48, v20
    v_xor_b32 v25, 64, v21
    v_add_u32 v8, v20, v21
    v_add_u32 v9, v20, v25
    v_add_u32 v9, 3072, v9
    v_add_u32 v10, v20, v21
    v_add_u32 v10, 6144, v10
    v_add_u32 v11, v20, v25
    v_add_u32 v11, 9216, v11
    v_lshl_add_u32 v12, v22, 9, v24
    v_add_u32 v13, 3072, v12
    v_add_u32 v14, 6144, v12
    v_add_u32 v15, 9216, v12
    s_lshl_b32 s48, s44, 6
    v_add_u32 v20, s48, v22
    v_mul_u32_u24 v20, 896, v20
    v_add_u32 v16, v20, v23
    v_add_u32 v17, 6144, v16
    v_add_u32 v18, 12288, v16
    v_add_u32 v19, 18432, v16
    s_add_u32 m0, s50, 8192
    s_mov_b32 s46, s85
    buffer_load_dwordx4 v2, s[20:23], s46 offen lds
    buffer_load_dwordx4 v3, s[20:23], s46 offen offset:1024 lds
    s_add_u32 m0, s45, 8192
    s_lshl_b32 s46, s85, 12
    buffer_load_dwordx4 v4, s[24:27], s46 offen lds
    buffer_load_dwordx4 v5, s[24:27], s46 offen offset:1024 lds
    buffer_load_dwordx4 v6, s[24:27], s46 offen offset:2048 lds
    buffer_load_dwordx4 v7, s[24:27], s46 offen offset:3072 lds
    s_add_u32 m0, s45, 12288
    s_lshl_b32 s46, s85, 12
    s_add_u32 s46, s46, 262144
    buffer_load_dwordx4 v4, s[24:27], s46 offen lds
    buffer_load_dwordx4 v5, s[24:27], s46 offen offset:1024 lds
    buffer_load_dwordx4 v6, s[24:27], s46 offen offset:2048 lds
    buffer_load_dwordx4 v7, s[24:27], s46 offen offset:3072 lds
    s_waitcnt vmcnt(10)
    s_barrier
    s_add_u32 m0, s50, 16384
    s_mov_b32 s46, s86
    buffer_load_dwordx4 v2, s[20:23], s46 offen lds
    buffer_load_dwordx4 v3, s[20:23], s46 offen offset:1024 lds
    s_add_u32 m0, s45, 16384
    s_lshl_b32 s46, s86, 12
    buffer_load_dwordx4 v4, s[24:27], s46 offen lds
    buffer_load_dwordx4 v5, s[24:27], s46 offen offset:1024 lds
    buffer_load_dwordx4 v6, s[24:27], s46 offen offset:2048 lds
    buffer_load_dwordx4 v7, s[24:27], s46 offen offset:3072 lds
    s_add_u32 m0, s45, 20480
    s_lshl_b32 s46, s86, 12
    s_add_u32 s46, s46, 262144
    buffer_load_dwordx4 v4, s[24:27], s46 offen lds
    buffer_load_dwordx4 v5, s[24:27], s46 offen offset:1024 lds
    buffer_load_dwordx4 v6, s[24:27], s46 offen offset:2048 lds
    buffer_load_dwordx4 v7, s[24:27], s46 offen offset:3072 lds
    s_getpc_b64 s[98:99]
L_pcref:
    s_lshl_b32 s48, s54, 2
    s_add_u32 s48, s48, s44
    s_lshl_b32 s48, s48, 2
    v_add_u32 v20, s48, v0
    v_lshlrev_b32 v20, 7, v20
    v_cmp_gt_u32 vcc, L_end-L_code0, v20
    v_cmp_gt_u32 s[100:101], 4, v0
    s_nop 3
    s_and_b64 vcc, vcc, s[100:101]
    s_sub_u32 s98, s98, L_pcref-L_code0
    s_subb_u32 s99, s99, 0
    s_and_saveexec_b64 s[100:101], vcc
    global_load_dword v26, v20, s[98:99]
    s_mov_b64 exec, s[100:101]
    s_waitcnt vmcnt(11)
    s_barrier
    s_add_u32 m0, s50, 24576
    s_mov_b32 s46, s87
    buffer_load_dwordx4 v2, s[20:23], s46 offen lds
    buffer_load_dwordx4 v3, s[20:23], s46 offen offset:1024 lds
    s_add_u32 m0, s45, 0
    s_lshl_b32 s46, s87, 12
    buffer_load_dwordx4 v4, s[24:27], s46 offen lds
    buffer_load_dwordx4 v5, s[24:27], s46 offen offset:1024 lds
    buffer_load_dwordx4 v6, s[24:27], s46 offen offset:2048 lds
    buffer_load_dwordx4 v7, s[24:27], s46 offen offset:3072 lds
    s_add_u32 m0, s45, 4096
    s_lshl_b32 s46, s87, 12
    s_add_u32 s46, s46, 262144
    buffer_load_dwordx4 v4, s[24:27], s46 offen lds
    buffer_load_dwordx4 v5, s[24:27], s46 offen offset:1024 lds
    buffer_load_dwordx4 v6, s[24:27], s46 offen offset:2048 lds
    buffer_load_dwordx4 v7, s[24:27], s46 offen offset:3072 lds
    s_waitcnt vmcnt(11)
    s_barrier
    s_add_u32 m0, s50, 32768
    s_mov_b32 s46, s88
    buffer_load_dwordx4 v2, s[20:23], s46 offen lds
    buffer_load_dwordx4 v3, s[20:23], s46 offen offset:1024 lds
    s_add_u32 m0, s45, 8192
    s_lshl_b32 s46, s88, 12
    buffer_load_dwordx4 v4, s[24:27], s46 offen lds
    buffer_load_dwordx4 v5, s[24:27], s46 offen offset:1024 lds
    buffer_load_dwordx4 v6, s[24:27], s46 offen offset:2048 lds
    buffer_load_dwordx4 v7, s[24:27], s46 offen offset:3072 lds
    s_add_u32 m0, s45, 12288
    s_lshl_b32 s46, s88, 12
    s_add_u32 s46, s46, 262144
    buffer_load_dwordx4 v4, s[24:27], s46 offen lds
    buffer_load_dwordx4 v5, s[24:27], s46 offen offset:1024 lds
    buffer_load_dwordx4 v6, s[24:27], s46 offen offset:2048 lds
    buffer_load_dwordx4 v7, s[24:27], s46 offen offset:3072 lds
    s_waitcnt vmcnt(10)
    s_barrier
    s_add_u32 m0, s50, 40960
    s_mov_b32 s46, s89
    buffer_load_dwordx4 v2, s[20:23], s46 offen lds
    buffer_load_dwordx4 v3, s[20:23], s46 offen offset:1024 lds
    s_add_u32 m0, s45, 16384
    s_lshl_b32 s46, s89, 12
    buffer_load_dwordx4 v4, s[24:27], s46 offen lds
    buffer_load_dwordx4 v5, s[24:27], s46 offen offset:1024 lds
    buffer_load_dwordx4 v6, s[24:27], s46 offen offset:2048 lds
    buffer_load_dwordx4 v7, s[24:27], s46 offen offset:3072 lds
    s_add_u32 m0, s45, 20480
    s_lshl_b32 s46, s89, 12
    s_add_u32 s46, s46, 262144
    buffer_load_dwordx4 v4, s[24:27], s46 offen lds
    buffer_load_dwordx4 v5, s[24:27], s46 offen offset:1024 lds
    buffer_load_dwordx4 v6, s[24:27], s46 offen offset:2048 lds
    buffer_load_dwordx4 v7, s[24:27], s46 offen offset:3072 lds
    s_waitcnt vmcnt(10)
    s_barrier
    s_add_u32 m0, s50, 49152
    s_mov_b32 s46, s90
    buffer_load_dwordx4 v2, s[20:23], s46 offen lds
    buffer_load_dwordx4 v3, s[20:23], s46 offen offset:1024 lds
    s_add_u32 m0, s45, 0
    s_lshl_b32 s46, s90, 12
    buffer_load_dwordx4 v4, s[24:27], s46 offen lds
    buffer_load_dwordx4 v5, s[24:27], s46 offen offset:1024 lds
    buffer_load_dwordx4 v6, s[24:27], s46 offen offset:2048 lds
    buffer_load_dwordx4 v7, s[24:27], s46 offen offset:3072 lds
    s_add_u32 m0, s45, 4096
    s_lshl_b32 s46, s90, 12
    s_add_u32 s46, s46, 262144
    buffer_load_dwordx4 v4, s[24:27], s46 offen lds
    buffer_load_dwordx4 v5, s[24:27], s46 offen offset:1024 lds
    buffer_load_dwordx4 v6, s[24:27], s46 offen offset:2048 lds
    buffer_load_dwordx4 v7, s[24:27], s46 offen offset:3072 lds
    s_waitcnt vmcnt(10)
    s_barrier
    s_add_u32 m0, s45, 8192
    s_add_u32 s46, s80, 0
    buffer_load_dwordx4 v8, s[28:31], s46 offen lds
    buffer_load_dwordx4 v9, s[28:31], s46 offen offset:1024 lds
    buffer_load_dwordx4 v10, s[28:31], s46 offen offset:2048 lds
    buffer_load_dwordx4 v11, s[28:31], s46 offen offset:3072 lds
    s_add_u32 m0, s45, 12288
    s_add_u32 s46, s80, 128
    buffer_load_dwordx4 v8, s[28:31], s46 offen lds
    buffer_load_dwordx4 v9, s[28:31], s46 offen offset:1024 lds
    buffer_load_dwordx4 v10, s[28:31], s46 offen offset:2048 lds
    buffer_load_dwordx4 v11, s[28:31], s46 offen offset:3072 lds
    s_waitcnt vmcnt(8)
    s_barrier
    s_add_u32 m0, s45, 16384
    s_add_u32 s46, s81, 0
    buffer_load_dwordx4 v8, s[28:31], s46 offen lds
    buffer_load_dwordx4 v9, s[28:31], s46 offen offset:1024 lds
    buffer_load_dwordx4 v10, s[28:31], s46 offen offset:2048 lds
    buffer_load_dwordx4 v11, s[28:31], s46 offen offset:3072 lds
    s_add_u32 m0, s45, 20480
    s_add_u32 s46, s81, 128
    buffer_load_dwordx4 v8, s[28:31], s46 offen lds
    buffer_load_dwordx4 v9, s[28:31], s46 offen offset:1024 lds
    buffer_load_dwordx4 v10, s[28:31], s46 offen offset:2048 lds
    buffer_load_dwordx4 v11, s[28:31], s46 offen offset:3072 lds
    s_waitcnt vmcnt(8)
    s_barrier
    s_add_u32 m0, s45, 0
    s_add_u32 s46, s82, 0
    buffer_load_dwordx4 v8, s[28:31], s46 offen lds
    buffer_load_dwordx4 v9, s[28:31], s46 offen offset:1024 lds
    buffer_load_dwordx4 v10, s[28:31], s46 offen offset:2048 lds
    buffer_load_dwordx4 v11, s[28:31], s46 offen offset:3072 lds
    s_add_u32 m0, s45, 4096
    s_add_u32 s46, s82, 128
    buffer_load_dwordx4 v8, s[28:31], s46 offen lds
    buffer_load_dwordx4 v9, s[28:31], s46 offen offset:1024 lds
    buffer_load_dwordx4 v10, s[28:31], s46 offen offset:2048 lds
    buffer_load_dwordx4 v11, s[28:31], s46 offen offset:3072 lds
    s_waitcnt vmcnt(8)
    s_barrier
    s_add_u32 m0, s45, 8192
    s_add_u32 s46, s83, 0
    buffer_load_dwordx4 v8, s[28:31], s46 offen lds
    buffer_load_dwordx4 v9, s[28:31], s46 offen offset:1024 lds
    buffer_load_dwordx4 v10, s[28:31], s46 offen offset:2048 lds
    buffer_load_dwordx4 v11, s[28:31], s46 offen offset:3072 lds
    s_add_u32 m0, s45, 12288
    s_add_u32 s46, s83, 128
    buffer_load_dwordx4 v8, s[28:31], s46 offen lds
    buffer_load_dwordx4 v9, s[28:31], s46 offen offset:1024 lds
    buffer_load_dwordx4 v10, s[28:31], s46 offen offset:2048 lds
    buffer_load_dwordx4 v11, s[28:31], s46 offen offset:3072 lds
    s_waitcnt vmcnt(8)
    s_barrier
    s_add_u32 m0, s45, 16384
    s_add_u32 s46, s80, 256
    buffer_load_dwordx4 v8, s[28:31], s46 offen lds
    buffer_load_dwordx4 v9, s[28:31], s46 offen offset:1024 lds
    buffer_load_dwordx4 v10, s[28:31], s46 offen offset:2048 lds
    buffer_load_dwordx4 v11, s[28:31], s46 offen offset:3072 lds
    s_add_u32 m0, s45, 20480
    s_add_u32 s46, s80, 384
    buffer_load_dwordx4 v8, s[28:31], s46 offen lds
    buffer_load_dwordx4 v9, s[28:31], s46 offen offset:1024 lds
    buffer_load_dwordx4 v10, s[28:31], s46 offen offset:2048 lds
    buffer_load_dwordx4 v11, s[28:31], s46 offen offset:3072 lds
    s_waitcnt vmcnt(8)
    s_barrier
    s_add_u32 m0, s45, 0
    s_add_u32 s46, s81, 256
    buffer_load_dwordx4 v8, s[28:31], s46 offen lds
    buffer_load_dwordx4 v9, s[28:31], s46 offen offset:1024 lds
    buffer_load_dwordx4 v10, s[28:31], s46 offen offset:2048 lds
    buffer_load_dwordx4 v11, s[28:31], s46 offen offset:3072 lds
    s_add_u32 m0, s45, 4096
    s_add_u32 s46, s81, 384
    buffer_load_dwordx4 v8, s[28:31], s46 offen lds
    buffer_load_dwordx4 v9, s[28:31], s46 offen offset:1024 lds
    buffer_load_dwordx4 v10, s[28:31], s46 offen offset:2048 lds
    buffer_load_dwordx4 v11, s[28:31], s46 offen offset:3072 lds
    s_waitcnt vmcnt(8)
    s_barrier
    s_add_u32 m0, s45, 8192
    s_add_u32 s46, s82, 256
    buffer_load_dwordx4 v8, s[28:31], s46 offen lds
    buffer_load_dwordx4 v9, s[28:31], s46 offen offset:1024 lds
    buffer_load_dwordx4 v10, s[28:31], s46 offen offset:2048 lds
    buffer_load_dwordx4 v11, s[28:31], s46 offen offset:3072 lds
    s_add_u32 m0, s45, 12288
    s_add_u32 s46, s82, 384
    buffer_load_dwordx4 v8, s[28:31], s46 offen lds
    buffer_load_dwordx4 v9, s[28:31], s46 offen offset:1024 lds
    buffer_load_dwordx4 v10, s[28:31], s46 offen offset:2048 lds
    buffer_load_dwordx4 v11, s[28:31], s46 offen offset:3072 lds
    s_waitcnt vmcnt(8)
    s_barrier
    s_add_u32 m0, s45, 16384
    s_add_u32 s46, s83, 256
    buffer_load_dwordx4 v8, s[28:31], s46 offen lds
    buffer_load_dwordx4 v9, s[28:31], s46 offen offset:1024 lds
    buffer_load_dwordx4 v10, s[28:31], s46 offen offset:2048 lds
    buffer_load_dwordx4 v11, s[28:31], s46 offen offset:3072 lds
    s_add_u32 m0, s45, 20480
    s_add_u32 s46, s83, 384
    buffer_load_dwordx4 v8, s[28:31], s46 offen lds
    buffer_load_dwordx4 v9, s[28:31], s46 offen offset:1024 lds
    buffer_load_dwordx4 v10, s[28:31], s46 offen offset:2048 lds
    buffer_load_dwordx4 v11, s[28:31], s46 offen offset:3072 lds
    s_waitcnt vmcnt(8)
    s_barrier
    s_add_u32 m0, s45, 0
    s_add_u32 s46, s80, 0
    buffer_load_dwordx4 v12, s[32:35], s46 offen lds
    buffer_load_dwordx4 v13, s[32:35], s46 offen offset:1024 lds
    buffer_load_dwordx4 v14, s[32:35], s46 offen offset:2048 lds
    buffer_load_dwordx4 v15, s[32:35], s46 offen offset:3072 lds
    s_add_u32 m0, s45, 4096
    s_add_u32 s46, s80, 16384
    buffer_load_dwordx4 v12, s[32:35], s46 offen lds
    buffer_load_dwordx4 v13, s[32:35], s46 offen offset:1024 lds
    buffer_load_dwordx4 v14, s[32:35], s46 offen offset:2048 lds
    buffer_load_dwordx4 v15, s[32:35], s46 offen offset:3072 lds
    s_waitcnt vmcnt(8)
    s_barrier
    s_add_u32 m0, s45, 8192
    s_add_u32 s46, s80, 32768
    buffer_load_dwordx4 v12, s[32:35], s46 offen lds
    buffer_load_dwordx4 v13, s[32:35], s46 offen offset:1024 lds
    buffer_load_dwordx4 v14, s[32:35], s46 offen offset:2048 lds
    buffer_load_dwordx4 v15, s[32:35], s46 offen offset:3072 lds
    s_add_u32 m0, s45, 12288
    s_add_u32 s46, s80, 49152
    buffer_load_dwordx4 v12, s[32:35], s46 offen lds
    buffer_load_dwordx4 v13, s[32:35], s46 offen offset:1024 lds
    buffer_load_dwordx4 v14, s[32:35], s46 offen offset:2048 lds
    buffer_load_dwordx4 v15, s[32:35], s46 offen offset:3072 lds
    s_waitcnt vmcnt(8)
    s_barrier
    s_add_u32 m0, s45, 16384
    s_add_u32 s46, s81, 0
    buffer_load_dwordx4 v12, s[32:35], s46 offen lds
    buffer_load_dwordx4 v13, s[32:35], s46 offen offset:1024 lds
    buffer_load_dwordx4 v14, s[32:35], s46 offen offset:2048 lds
    buffer_load_dwordx4 v15, s[32:35], s46 offen offset:3072 lds
    s_add_u32 m0, s45, 20480
    s_add_u32 s46, s81, 16384
    buffer_load_dwordx4 v12, s[32:35], s46 offen lds
    buffer_load_dwordx4 v13, s[32:35], s46 offen offset:1024 lds
    buffer_load_dwordx4 v14, s[32:35], s46 offen offset:2048 lds
    buffer_load_dwordx4 v15, s[32:35], s46 offen offset:3072 lds
    s_barrier
    s_waitcnt vmcnt(8)
    s_barrier
    s_add_u32 m0, s45, 0
    s_add_u32 s46, s81, 32768
    buffer_load_dwordx4 v12, s[32:35], s46 offen lds
    buffer_load_dwordx4 v13, s[32:35], s46 offen offset:1024 lds
    buffer_load_dwordx4 v14, s[32:35], s46 offen offset:2048 lds
    buffer_load_dwordx4 v15, s[32:35], s46 offen offset:3072 lds
    s_add_u32 m0, s45, 4096
    s_add_u32 s46, s81, 49152
    buffer_load_dwordx4 v12, s[32:35], s46 offen lds
    buffer_load_dwordx4 v13, s[32:35], s46 offen offset:1024 lds
    buffer_load_dwordx4 v14, s[32:35], s46 offen offset:2048 lds
    buffer_load_dwordx4 v15, s[32:35], s46 offen offset:3072 lds
    s_waitcnt vmcnt(8)
    s_barrier
    s_add_u32 m0, s45, 8192
    s_add_u32 s46, s82, 0
    buffer_load_dwordx4 v12, s[32:35], s46 offen lds
    buffer_load_dwordx4 v13, s[32:35], s46 offen offset:1024 lds
    buffer_load_dwordx4 v14, s[32:35], s46 offen offset:2048 lds
    buffer_load_dwordx4 v15, s[32:35], s46 offen offset:3072 lds
    s_add_u32 m0, s45, 12288
    s_add_u32 s46, s82, 16384
    buffer_load_dwordx4 v12, s[32:35], s46 offen lds
    buffer_load_dwordx4 v13, s[32:35], s46 offen offset:1024 lds
    buffer_load_dwordx4 v14, s[32:35], s46 offen offset:2048 lds
    buffer_load_dwordx4 v15, s[32:35], s46 offen offset:3072 lds
    s_waitcnt vmcnt(8)
    s_barrier
    s_add_u32 m0, s45, 16384
    s_add_u32 s46, s82, 32768
    buffer_load_dwordx4 v12, s[32:35], s46 offen lds
    buffer_load_dwordx4 v13, s[32:35], s46 offen offset:1024 lds
    buffer_load_dwordx4 v14, s[32:35], s46 offen offset:2048 lds
    buffer_load_dwordx4 v15, s[32:35], s46 offen offset:3072 lds
    s_add_u32 m0, s45, 20480
    s_add_u32 s46, s82, 49152
    buffer_load_dwordx4 v12, s[32:35], s46 offen lds
    buffer_load_dwordx4 v13, s[32:35], s46 offen offset:1024 lds
    buffer_load_dwordx4 v14, s[32:35], s46 offen offset:2048 lds
    buffer_load_dwordx4 v15, s[32:35], s46 offen offset:3072 lds
    s_waitcnt vmcnt(8)
    s_barrier
    s_add_u32 m0, s45, 0
    s_add_u32 s46, s83, 0
    buffer_load_dwordx4 v12, s[32:35], s46 offen lds
    buffer_load_dwordx4 v13, s[32:35], s46 offen offset:1024 lds
    buffer_load_dwordx4 v14, s[32:35], s46 offen offset:2048 lds
    buffer_load_dwordx4 v15, s[32:35], s46 offen offset:3072 lds
    s_add_u32 m0, s45, 4096
    s_add_u32 s46, s83, 16384
    buffer_load_dwordx4 v12, s[32:35], s46 offen lds
    buffer_load_dwordx4 v13, s[32:35], s46 offen offset:1024 lds
    buffer_load_dwordx4 v14, s[32:35], s46 offen offset:2048 lds
    buffer_load_dwordx4 v15, s[32:35], s46 offen offset:3072 lds
    s_waitcnt vmcnt(8)
    s_barrier
    s_add_u32 m0, s45, 8192
    s_add_u32 s46, s83, 32768
    buffer_load_dwordx4 v12, s[32:35], s46 offen lds
    buffer_load_dwordx4 v13, s[32:35], s46 offen offset:1024 lds
    buffer_load_dwordx4 v14, s[32:35], s46 offen offset:2048 lds
    buffer_load_dwordx4 v15, s[32:35], s46 offen offset:3072 lds
    s_add_u32 m0, s45, 12288
    s_add_u32 s46, s83, 49152
    buffer_load_dwordx4 v12, s[32:35], s46 offen lds
    buffer_load_dwordx4 v13, s[32:35], s46 offen offset:1024 lds
    buffer_load_dwordx4 v14, s[32:35], s46 offen offset:2048 lds
    buffer_load_dwordx4 v15, s[32:35], s46 offen offset:3072 lds
    s_waitcnt vmcnt(8)
    s_barrier
    s_add_u32 m0, s45, 16384
    s_add_u32 s46, s91, 0
    buffer_load_dwordx4 v16, s[36:39], s46 offen lds
    buffer_load_dwordx4 v17, s[36:39], s46 offen offset:1024 lds
    buffer_load_dwordx4 v18, s[36:39], s46 offen offset:2048 lds
    buffer_load_dwordx4 v19, s[36:39], s46 offen offset:3072 lds
    s_add_u32 m0, s45, 20480
    s_add_u32 s46, s91, 28672
    buffer_load_dwordx4 v16, s[36:39], s46 offen lds
    buffer_load_dwordx4 v17, s[36:39], s46 offen offset:1024 lds
    buffer_load_dwordx4 v18, s[36:39], s46 offen offset:2048 lds
    buffer_load_dwordx4 v19, s[36:39], s46 offen offset:3072 lds
    s_waitcnt vmcnt(8)
    s_barrier
    s_add_u32 m0, s45, 0
    s_add_u32 s46, s92, 0
    buffer_load_dwordx4 v16, s[36:39], s46 offen lds
    buffer_load_dwordx4 v17, s[36:39], s46 offen offset:1024 lds
    buffer_load_dwordx4 v18, s[36:39], s46 offen offset:2048 lds
    buffer_load_dwordx4 v19, s[36:39], s46 offen offset:3072 lds
    s_add_u32 m0, s45, 4096
    s_add_u32 s46, s92, 28672
    buffer_load_dwordx4 v16, s[36:39], s46 offen lds
    buffer_load_dwordx4 v17, s[36:39], s46 offen offset:1024 lds
    buffer_load_dwordx4 v18, s[36:39], s46 offen offset:2048 lds
    buffer_load_dwordx4 v19, s[36:39], s46 offen offset:3072 lds
    s_barrier
    s_waitcnt vmcnt(8)
    s_barrier
    s_add_u32 m0, s45, 8192
    s_add_u32 s46, s93, 0
    buffer_load_dwordx4 v16, s[36:39], s46 offen lds
    buffer_load_dwordx4 v17, s[36:39], s46 offen offset:1024 lds
    buffer_load_dwordx4 v18, s[36:39], s46 offen offset:2048 lds
    buffer_load_dwordx4 v19, s[36:39], s46 offen offset:3072 lds
    s_add_u32 m0, s45, 12288
    s_add_u32 s46, s93, 28672
    buffer_load_dwordx4 v16, s[36:39], s46 offen lds
    buffer_load_dwordx4 v17, s[36:39], s46 offen offset:1024 lds
    buffer_load_dwordx4 v18, s[36:39], s46 offen offset:2048 lds
    buffer_load_dwordx4 v19, s[36:39], s46 offen offset:3072 lds
    s_waitcnt vmcnt(8)
    s_barrier
    s_add_u32 m0, s52, 0
    s_add_u32 s46, s94, 0
    buffer_load_dwordx4 v16, s[36:39], s46 offen lds
    buffer_load_dwordx4 v17, s[36:39], s46 offen offset:1024 lds
    buffer_load_dwordx4 v18, s[36:39], s46 offen offset:2048 lds
    buffer_load_dwordx4 v19, s[36:39], s46 offen offset:3072 lds
    s_add_u32 m0, s52, 4096
    s_add_u32 s46, s94, 28672
    buffer_load_dwordx4 v16, s[36:39], s46 offen lds
    buffer_load_dwordx4 v17, s[36:39], s46 offen offset:1024 lds
    buffer_load_dwordx4 v18, s[36:39], s46 offen offset:2048 lds
    buffer_load_dwordx4 v19, s[36:39], s46 offen offset:3072 lds
    s_add_u32 m0, s52, 32768
    s_add_u32 s46, s95, 0
    buffer_load_dwordx4 v16, s[36:39], s46 offen lds
    buffer_load_dwordx4 v17, s[36:39], s46 offen offset:1024 lds
    buffer_load_dwordx4 v18, s[36:39], s46 offen offset:2048 lds
    buffer_load_dwordx4 v19, s[36:39], s46 offen offset:3072 lds
    s_add_u32 m0, s52, 36864
    s_add_u32 s46, s95, 28672
    buffer_load_dwordx4 v16, s[36:39], s46 offen lds
    buffer_load_dwordx4 v17, s[36:39], s46 offen offset:1024 lds
    buffer_load_dwordx4 v18, s[36:39], s46 offen offset:2048 lds
    buffer_load_dwordx4 v19, s[36:39], s46 offen offset:3072 lds
    s_waitcnt vmcnt(16)
    s_barrier
    s_add_u32 m0, s45, 16384
    s_add_u32 s46, s96, 0
    buffer_load_dwordx4 v16, s[36:39], s46 offen lds
    buffer_load_dwordx4 v17, s[36:39], s46 offen offset:1024 lds
    buffer_load_dwordx4 v18, s[36:39], s46 offen offset:2048 lds
    buffer_load_dwordx4 v19, s[36:39], s46 offen offset:3072 lds
    s_add_u32 m0, s45, 20480
    s_add_u32 s46, s96, 28672
    buffer_load_dwordx4 v16, s[36:39], s46 offen lds
    buffer_load_dwordx4 v17, s[36:39], s46 offen offset:1024 lds
    buffer_load_dwordx4 v18, s[36:39], s46 offen offset:2048 lds
    buffer_load_dwordx4 v19, s[36:39], s46 offen offset:3072 lds
    s_waitcnt vmcnt(16)
    s_barrier
    s_add_u32 m0, s45, 0
    s_add_u32 s46, s97, 0
    buffer_load_dwordx4 v16, s[36:39], s46 offen lds
    buffer_load_dwordx4 v17, s[36:39], s46 offen offset:1024 lds
    buffer_load_dwordx4 v18, s[36:39], s46 offen offset:2048 lds
    buffer_load_dwordx4 v19, s[36:39], s46 offen offset:3072 lds
    s_add_u32 m0, s45, 4096
    s_add_u32 s46, s97, 28672
    buffer_load_dwordx4 v16, s[36:39], s46 offen lds
    buffer_load_dwordx4 v17, s[36:39], s46 offen offset:1024 lds
    buffer_load_dwordx4 v18, s[36:39], s46 offen offset:2048 lds
    buffer_load_dwordx4 v19, s[36:39], s46 offen offset:3072 lds
    s_waitcnt vmcnt(16)
    s_barrier
    s_waitcnt vmcnt(8)
    s_barrier
    s_waitcnt vmcnt(0)
    s_barrier
    s_endpgm
L_end:
    s_endpgm
.globl gqa_reduce_kernel
.p2align 8
.type gqa_reduce_kernel,@function
gqa_reduce_kernel:
    s_cmp_ge_u32 s2, 224
    s_cbranch_scc1 L_rend
    s_load_dwordx2 s[4:5], s[0:1], 40
    s_load_dwordx2 s[6:7], s[0:1], 56
    v_lshrrev_b32 v2, 6, v0
    v_and_b32 v1, 63, v0
    v_readfirstlane_b32 s8, v2
    s_lshl_b32 s9, s2, 2
    s_nop 2
    s_add_u32 s9, s9, s8
    s_mul_i32 s10, s9, 1171
    s_lshr_b32 s10, s10, 16
    s_mul_i32 s11, s10, 56
    s_sub_u32 s11, s9, s11
    s_mul_i32 s14, s10, 917504
    s_lshl_b32 s15, s11, 10
    s_add_u32 s14, s14, s15
    s_waitcnt lgkmcnt(0)
    s_add_u32 s20, s6, s14
    s_addc_u32 s21, s7, 0
    s_and_b32 s21, s21, 0xffff
    s_mov_b32 s22, 861184
    s_mov_b32 s23, 0x20000
    s_mov_b32 s24, s4
    s_and_b32 s25, s5, 0xffff
    s_mov_b32 s26, 917504
    s_mov_b32 s27, 0x20000
    v_lshlrev_b32 v3, 4, v1
    s_mov_b32 s28, 0
    buffer_load_dwordx4 v[8:11], v3, s[20:23], s28 offen
    s_mov_b32 s28, 57344
    buffer_load_dwordx4 v[12:15], v3, s[20:23], s28 offen
    s_mov_b32 s28, 114688
    buffer_load_dwordx4 v[16:19], v3, s[20:23], s28 offen
    s_mov_b32 s28, 172032
    buffer_load_dwordx4 v[20:23], v3, s[20:23], s28 offen
    s_mov_b32 s28, 229376
    buffer_load_dwordx4 v[24:27], v3, s[20:23], s28 offen
    s_mov_b32 s28, 286720
    buffer_load_dwordx4 v[28:31], v3, s[20:23], s28 offen
    s_mov_b32 s28, 344064
    buffer_load_dwordx4 v[32:35], v3, s[20:23], s28 offen
    s_mov_b32 s28, 401408
    buffer_load_dwordx4 v[36:39], v3, s[20:23], s28 offen
    s_mov_b32 s28, 458752
    buffer_load_dwordx4 v[40:43], v3, s[20:23], s28 offen
    s_mov_b32 s28, 516096
    buffer_load_dwordx4 v[44:47], v3, s[20:23], s28 offen
    s_mov_b32 s28, 573440
    buffer_load_dwordx4 v[48:51], v3, s[20:23], s28 offen
    s_mov_b32 s28, 630784
    buffer_load_dwordx4 v[52:55], v3, s[20:23], s28 offen
    s_mov_b32 s28, 688128
    buffer_load_dwordx4 v[56:59], v3, s[20:23], s28 offen
    s_mov_b32 s28, 745472
    buffer_load_dwordx4 v[60:63], v3, s[20:23], s28 offen
    s_mov_b32 s28, 802816
    buffer_load_dwordx4 v[64:67], v3, s[20:23], s28 offen
    s_mov_b32 s28, 860160
    buffer_load_dwordx4 v[68:71], v3, s[20:23], s28 offen
    s_lshr_b32 s12, s11, 3
    s_bfe_u32 s13, s11, 0x10002
    s_bfe_u32 s16, s11, 0x10001
    s_and_b32 s17, s11, 1
    s_lshl_b32 s15, s10, 6
    s_lshl_b32 s13, s13, 5
    s_add_u32 s15, s15, s13
    v_and_b32 v4, 31, v1
    v_add_u32 v4, s15, v4
    v_mul_u32_u24 v4, 896, v4
    s_lshl_b32 s12, s12, 7
    s_lshl_b32 s16, s16, 6
    s_lshl_b32 s17, s17, 5
    s_add_u32 s12, s12, s16
    s_add_u32 s12, s12, s17
    v_lshrrev_b32 v5, 5, v1
    v_lshlrev_b32 v5, 4, v5
    v_add3_u32 v4, v4, v5, s12
    s_waitcnt vmcnt(15)
    v_lshlrev_b32 v80, 16, v8
    v_and_b32 v81, 0xffff0000, v8
    v_lshlrev_b32 v82, 16, v9
    v_and_b32 v83, 0xffff0000, v9
    v_lshlrev_b32 v84, 16, v10
    v_and_b32 v85, 0xffff0000, v10
    v_lshlrev_b32 v86, 16, v11
    v_and_b32 v87, 0xffff0000, v11
    s_waitcnt vmcnt(14)
    v_lshlrev_b32 v6, 16, v12
    v_and_b32 v7, 0xffff0000, v12
    v_add_f32 v80, v80, v6
    v_add_f32 v81, v81, v7
    v_lshlrev_b32 v6, 16, v13
    v_and_b32 v7, 0xffff0000, v13
    v_add_f32 v82, v82, v6
    v_add_f32 v83, v83, v7
    v_lshlrev_b32 v6, 16, v14
    v_and_b32 v7, 0xffff0000, v14
    v_add_f32 v84, v84, v6
    v_add_f32 v85, v85, v7
    v_lshlrev_b32 v6, 16, v15
    v_and_b32 v7, 0xffff0000, v15
    v_add_f32 v86, v86, v6
    v_add_f32 v87, v87, v7
    s_waitcnt vmcnt(13)
    v_lshlrev_b32 v6, 16, v16
    v_and_b32 v7, 0xffff0000, v16
    v_add_f32 v80, v80, v6
    v_add_f32 v81, v81, v7
    v_lshlrev_b32 v6, 16, v17
    v_and_b32 v7, 0xffff0000, v17
    v_add_f32 v82, v82, v6
    v_add_f32 v83, v83, v7
    v_lshlrev_b32 v6, 16, v18
    v_and_b32 v7, 0xffff0000, v18
    v_add_f32 v84, v84, v6
    v_add_f32 v85, v85, v7
    v_lshlrev_b32 v6, 16, v19
    v_and_b32 v7, 0xffff0000, v19
    v_add_f32 v86, v86, v6
    v_add_f32 v87, v87, v7
    s_waitcnt vmcnt(12)
    v_lshlrev_b32 v6, 16, v20
    v_and_b32 v7, 0xffff0000, v20
    v_add_f32 v80, v80, v6
    v_add_f32 v81, v81, v7
    v_lshlrev_b32 v6, 16, v21
    v_and_b32 v7, 0xffff0000, v21
    v_add_f32 v82, v82, v6
    v_add_f32 v83, v83, v7
    v_lshlrev_b32 v6, 16, v22
    v_and_b32 v7, 0xffff0000, v22
    v_add_f32 v84, v84, v6
    v_add_f32 v85, v85, v7
    v_lshlrev_b32 v6, 16, v23
    v_and_b32 v7, 0xffff0000, v23
    v_add_f32 v86, v86, v6
    v_add_f32 v87, v87, v7
    s_waitcnt vmcnt(11)
    v_lshlrev_b32 v6, 16, v24
    v_and_b32 v7, 0xffff0000, v24
    v_add_f32 v80, v80, v6
    v_add_f32 v81, v81, v7
    v_lshlrev_b32 v6, 16, v25
    v_and_b32 v7, 0xffff0000, v25
    v_add_f32 v82, v82, v6
    v_add_f32 v83, v83, v7
    v_lshlrev_b32 v6, 16, v26
    v_and_b32 v7, 0xffff0000, v26
    v_add_f32 v84, v84, v6
    v_add_f32 v85, v85, v7
    v_lshlrev_b32 v6, 16, v27
    v_and_b32 v7, 0xffff0000, v27
    v_add_f32 v86, v86, v6
    v_add_f32 v87, v87, v7
    s_waitcnt vmcnt(10)
    v_lshlrev_b32 v6, 16, v28
    v_and_b32 v7, 0xffff0000, v28
    v_add_f32 v80, v80, v6
    v_add_f32 v81, v81, v7
    v_lshlrev_b32 v6, 16, v29
    v_and_b32 v7, 0xffff0000, v29
    v_add_f32 v82, v82, v6
    v_add_f32 v83, v83, v7
    v_lshlrev_b32 v6, 16, v30
    v_and_b32 v7, 0xffff0000, v30
    v_add_f32 v84, v84, v6
    v_add_f32 v85, v85, v7
    v_lshlrev_b32 v6, 16, v31
    v_and_b32 v7, 0xffff0000, v31
    v_add_f32 v86, v86, v6
    v_add_f32 v87, v87, v7
    s_waitcnt vmcnt(9)
    v_lshlrev_b32 v6, 16, v32
    v_and_b32 v7, 0xffff0000, v32
    v_add_f32 v80, v80, v6
    v_add_f32 v81, v81, v7
    v_lshlrev_b32 v6, 16, v33
    v_and_b32 v7, 0xffff0000, v33
    v_add_f32 v82, v82, v6
    v_add_f32 v83, v83, v7
    v_lshlrev_b32 v6, 16, v34
    v_and_b32 v7, 0xffff0000, v34
    v_add_f32 v84, v84, v6
    v_add_f32 v85, v85, v7
    v_lshlrev_b32 v6, 16, v35
    v_and_b32 v7, 0xffff0000, v35
    v_add_f32 v86, v86, v6
    v_add_f32 v87, v87, v7
    s_waitcnt vmcnt(8)
    v_lshlrev_b32 v6, 16, v36
    v_and_b32 v7, 0xffff0000, v36
    v_add_f32 v80, v80, v6
    v_add_f32 v81, v81, v7
    v_lshlrev_b32 v6, 16, v37
    v_and_b32 v7, 0xffff0000, v37
    v_add_f32 v82, v82, v6
    v_add_f32 v83, v83, v7
    v_lshlrev_b32 v6, 16, v38
    v_and_b32 v7, 0xffff0000, v38
    v_add_f32 v84, v84, v6
    v_add_f32 v85, v85, v7
    v_lshlrev_b32 v6, 16, v39
    v_and_b32 v7, 0xffff0000, v39
    v_add_f32 v86, v86, v6
    v_add_f32 v87, v87, v7
    s_waitcnt vmcnt(7)
    v_lshlrev_b32 v6, 16, v40
    v_and_b32 v7, 0xffff0000, v40
    v_add_f32 v80, v80, v6
    v_add_f32 v81, v81, v7
    v_lshlrev_b32 v6, 16, v41
    v_and_b32 v7, 0xffff0000, v41
    v_add_f32 v82, v82, v6
    v_add_f32 v83, v83, v7
    v_lshlrev_b32 v6, 16, v42
    v_and_b32 v7, 0xffff0000, v42
    v_add_f32 v84, v84, v6
    v_add_f32 v85, v85, v7
    v_lshlrev_b32 v6, 16, v43
    v_and_b32 v7, 0xffff0000, v43
    v_add_f32 v86, v86, v6
    v_add_f32 v87, v87, v7
    s_waitcnt vmcnt(6)
    v_lshlrev_b32 v6, 16, v44
    v_and_b32 v7, 0xffff0000, v44
    v_add_f32 v80, v80, v6
    v_add_f32 v81, v81, v7
    v_lshlrev_b32 v6, 16, v45
    v_and_b32 v7, 0xffff0000, v45
    v_add_f32 v82, v82, v6
    v_add_f32 v83, v83, v7
    v_lshlrev_b32 v6, 16, v46
    v_and_b32 v7, 0xffff0000, v46
    v_add_f32 v84, v84, v6
    v_add_f32 v85, v85, v7
    v_lshlrev_b32 v6, 16, v47
    v_and_b32 v7, 0xffff0000, v47
    v_add_f32 v86, v86, v6
    v_add_f32 v87, v87, v7
    s_waitcnt vmcnt(5)
    v_lshlrev_b32 v6, 16, v48
    v_and_b32 v7, 0xffff0000, v48
    v_add_f32 v80, v80, v6
    v_add_f32 v81, v81, v7
    v_lshlrev_b32 v6, 16, v49
    v_and_b32 v7, 0xffff0000, v49
    v_add_f32 v82, v82, v6
    v_add_f32 v83, v83, v7
    v_lshlrev_b32 v6, 16, v50
    v_and_b32 v7, 0xffff0000, v50
    v_add_f32 v84, v84, v6
    v_add_f32 v85, v85, v7
    v_lshlrev_b32 v6, 16, v51
    v_and_b32 v7, 0xffff0000, v51
    v_add_f32 v86, v86, v6
    v_add_f32 v87, v87, v7
    s_waitcnt vmcnt(4)
    v_lshlrev_b32 v6, 16, v52
    v_and_b32 v7, 0xffff0000, v52
    v_add_f32 v80, v80, v6
    v_add_f32 v81, v81, v7
    v_lshlrev_b32 v6, 16, v53
    v_and_b32 v7, 0xffff0000, v53
    v_add_f32 v82, v82, v6
    v_add_f32 v83, v83, v7
    v_lshlrev_b32 v6, 16, v54
    v_and_b32 v7, 0xffff0000, v54
    v_add_f32 v84, v84, v6
    v_add_f32 v85, v85, v7
    v_lshlrev_b32 v6, 16, v55
    v_and_b32 v7, 0xffff0000, v55
    v_add_f32 v86, v86, v6
    v_add_f32 v87, v87, v7
    s_waitcnt vmcnt(3)
    v_lshlrev_b32 v6, 16, v56
    v_and_b32 v7, 0xffff0000, v56
    v_add_f32 v80, v80, v6
    v_add_f32 v81, v81, v7
    v_lshlrev_b32 v6, 16, v57
    v_and_b32 v7, 0xffff0000, v57
    v_add_f32 v82, v82, v6
    v_add_f32 v83, v83, v7
    v_lshlrev_b32 v6, 16, v58
    v_and_b32 v7, 0xffff0000, v58
    v_add_f32 v84, v84, v6
    v_add_f32 v85, v85, v7
    v_lshlrev_b32 v6, 16, v59
    v_and_b32 v7, 0xffff0000, v59
    v_add_f32 v86, v86, v6
    v_add_f32 v87, v87, v7
    s_waitcnt vmcnt(2)
    v_lshlrev_b32 v6, 16, v60
    v_and_b32 v7, 0xffff0000, v60
    v_add_f32 v80, v80, v6
    v_add_f32 v81, v81, v7
    v_lshlrev_b32 v6, 16, v61
    v_and_b32 v7, 0xffff0000, v61
    v_add_f32 v82, v82, v6
    v_add_f32 v83, v83, v7
    v_lshlrev_b32 v6, 16, v62
    v_and_b32 v7, 0xffff0000, v62
    v_add_f32 v84, v84, v6
    v_add_f32 v85, v85, v7
    v_lshlrev_b32 v6, 16, v63
    v_and_b32 v7, 0xffff0000, v63
    v_add_f32 v86, v86, v6
    v_add_f32 v87, v87, v7
    s_waitcnt vmcnt(1)
    v_lshlrev_b32 v6, 16, v64
    v_and_b32 v7, 0xffff0000, v64
    v_add_f32 v80, v80, v6
    v_add_f32 v81, v81, v7
    v_lshlrev_b32 v6, 16, v65
    v_and_b32 v7, 0xffff0000, v65
    v_add_f32 v82, v82, v6
    v_add_f32 v83, v83, v7
    v_lshlrev_b32 v6, 16, v66
    v_and_b32 v7, 0xffff0000, v66
    v_add_f32 v84, v84, v6
    v_add_f32 v85, v85, v7
    v_lshlrev_b32 v6, 16, v67
    v_and_b32 v7, 0xffff0000, v67
    v_add_f32 v86, v86, v6
    v_add_f32 v87, v87, v7
    s_waitcnt vmcnt(0)
    v_lshlrev_b32 v6, 16, v68
    v_and_b32 v7, 0xffff0000, v68
    v_add_f32 v80, v80, v6
    v_add_f32 v81, v81, v7
    v_lshlrev_b32 v6, 16, v69
    v_and_b32 v7, 0xffff0000, v69
    v_add_f32 v82, v82, v6
    v_add_f32 v83, v83, v7
    v_lshlrev_b32 v6, 16, v70
    v_and_b32 v7, 0xffff0000, v70
    v_add_f32 v84, v84, v6
    v_add_f32 v85, v85, v7
    v_lshlrev_b32 v6, 16, v71
    v_and_b32 v7, 0xffff0000, v71
    v_add_f32 v86, v86, v6
    v_add_f32 v87, v87, v7
    v_cvt_pk_bf16_f32 v88, v80, v81
    v_cvt_pk_bf16_f32 v89, v82, v83
    v_cvt_pk_bf16_f32 v90, v84, v85
    v_cvt_pk_bf16_f32 v91, v86, v87
    buffer_store_dwordx4 v[88:91], v4, s[24:27], 0 offen
L_rend:
    s_endpgm
.section .rodata,"a"
.p2align 6
.amdhsa_kernel standalone__gqa_block_cached__near_ridge_kernel
  .amdhsa_next_free_vgpr 256
  .amdhsa_next_free_sgpr 102
  .amdhsa_accum_offset 256
  .amdhsa_group_segment_fixed_size 0
  .amdhsa_kernarg_size 64
  .amdhsa_user_sgpr_count 2
  .amdhsa_user_sgpr_kernarg_segment_ptr 1
  .amdhsa_system_sgpr_workgroup_id_x 1
  .amdhsa_float_denorm_mode_32 3
.end_amdhsa_kernel
.p2align 6
.amdhsa_kernel gqa_reduce_kernel
  .amdhsa_next_free_vgpr 96
  .amdhsa_next_free_sgpr 40
  .amdhsa_accum_offset 96
  .amdhsa_group_segment_fixed_size 0
  .amdhsa_kernarg_size 64
  .amdhsa_user_sgpr_count 2
  .amdhsa_user_sgpr_kernarg_segment_ptr 1
  .amdhsa_system_sgpr_workgroup_id_x 1
  .amdhsa_float_denorm_mode_32 3
.end_amdhsa_kernel
```
